```python
import torch

def _softmax(x, axis=-1):
    return torch.softmax(x, dim=axis)
def _gelu(x):
    return torch.nn.functional.gelu(x, approximate="tanh")
def _silu(x):
    return torch.nn.functional.silu(x)
def _sigmoid(x):
    return torch.sigmoid(x)
def _layernorm(x, axis=-1, eps=1e-5):
    m = x.mean(dim=axis, keepdim=True)
    v = x.var(dim=axis, keepdim=True, unbiased=False)
    return (x - m) / torch.sqrt(v + eps)
def _scatter_add(tgt, idx, src, axis=0):
    return tgt.clone().index_add_(axis, idx, src)
def _segment_sum(src, seg, n):
    out = torch.zeros((n,) + src.shape[1:], dtype=src.dtype)
    return out.index_add_(0, seg, src)
def _pad(x, pw):
    flat = tuple(v for pair in reversed(pw) for v in pair)
    return torch.nn.functional.pad(x, flat)

kernel_name = 'recurrent_scan__spectral_gfnet__swiglu_ffn__prompt'

def setup_inputs():

    _w = (lambda a: (lambda t: t.to(torch.bfloat16) if t.is_floating_point() else t)(torch.as_tensor(a)))
    def _A_setup():
        B, S, D = 1, 2048, 448
        Df = D // 2 + 1
        return {
            "x": _w((lambda *s: torch.randn(*s, dtype=torch.bfloat16) * 0.05)(B, S, D)),
            "w_r": _w((lambda *s: torch.randn(*s, dtype=torch.bfloat16) * 0.2)(S, Df) * 0.02),
            "w_i": _w((lambda *s: torch.randn(*s, dtype=torch.bfloat16) * 0.2)(S, Df) * 0.02),
        }
    _A_in = _A_setup()

    def _B_setup():
        B, S, D, F = 1, 2048, 448, 1792
        return {
            "x": _w((lambda *s: torch.randn(*s, dtype=torch.bfloat16) * 0.05)(B, S, D)),
            "w_gate": _w((lambda *s: torch.randn(*s, dtype=torch.bfloat16) * 0.2)(D, F)),
            "w_up": _w((lambda *s: torch.randn(*s, dtype=torch.bfloat16) * 0.2)(D, F)),
            "w_down": _w((lambda *s: torch.randn(*s, dtype=torch.bfloat16) * 0.2)(F, D)),
        }
    _B_in = _B_setup()

    return {
        "A_x": _A_in["x"],
        "A_w_r": _A_in["w_r"],
        "A_w_i": _A_in["w_i"],
        "B_x": _B_in["x"],
        "B_w_gate": _B_in["w_gate"],
        "B_w_up": _B_in["w_up"],
        "B_w_down": _B_in["w_down"],
    }

def reference(A_x, A_w_r, A_w_i, B_x, B_w_gate, B_w_up, B_w_down):
    def _A_ref(x, w_r, w_i):
        B, S, D = x.shape
        X = (lambda x, axes=(-2,-1): torch.fft.rfft2(x.float(), dim=axes))(x, axes=(-2, -1))
        W = w_r + 1j * w_i
        X = X * W
        y = (lambda x, s, axes=(-2,-1): torch.fft.irfft2(x, s=s, dim=axes).to(torch.bfloat16))(X, (S, D), axes=(-2, -1))
        return y

    def _B_ref(x, w_gate, w_up, w_down):
        g = _silu(x @ w_gate)
        u = x @ w_up
        return (g * u) @ w_down

    x = A_x
    xn = _layernorm(x, axis=-1)
    s = _A_ref(xn, A_w_r, A_w_i)
    g = _silu(_B_ref(xn, B_w_gate, B_w_up, B_w_down))
    return x + s * g
```

```asm
; @launch grid=(256,1,1) block=(512,1,1) lds=163840
.amdgcn_target "amdgcn-amd-amdhsa--gfx950"
.text
.globl recurrent_scan__spectral_gfnet__swiglu_ffn__prompt_kernel
.p2align 8
.type recurrent_scan__spectral_gfnet__swiglu_ffn__prompt_kernel,@function
recurrent_scan__spectral_gfnet__swiglu_ffn__prompt_kernel:
    s_cmpk_ge_u32 s2, 256
    s_cbranch_scc1 L_end
    s_load_dwordx2 s[4:5], s[0:1], 0
    s_load_dwordx2 s[16:17], s[0:1], 72
    s_getpc_b64 s[44:45]
    v_and_b32 v1, 0x1c0, v0
    s_lshr_b32 s59, s2, 3
    s_lshl_b32 s46, s59, 10
    v_lshl_add_u32 v1, v1, 1, s46
    global_load_dword v23, v1, s[44:45]
    v_lshrrev_b32 v2, 6, v0
    s_cmpk_ge_u32 s2, 224
    s_cbranch_scc1 L_spare
    s_load_dwordx2 s[24:25], s[0:1], 48
    v_readfirstlane_b32 s28, v2
    v_bfe_u32 v1, v0, 3, 2
    s_bfe_u32 s44, s2, 0x20001
    v_bfe_u32 v3, v0, 5, 3
    s_and_b32 s45, s59, 3
    v_lshl_or_b32 v1, v1, 5, v3
    s_lshr_b32 s3, s59, 2
    v_bfe_u32 v3, v0, 4, 2
    s_lshr_b32 s34, s44, 1
    v_mul_u32_u24 v1, 896, v1
    s_add_u32 s34, s34, s3
    v_xor_b32 v3, v3, v0
    s_lshr_b32 s30, s28, 2
    s_add_u32 s46, s45, s30
    s_and_b32 s46, s46, 3
    s_lshl1_add_u32 s42, s46, s34
    v_and_b32 v3, 7, v3
    s_sub_u32 s46, s42, 7
    v_lshl_add_u32 v132, v3, 4, v1
    s_cselect_b32 s42, s42, s46
    v_xor_b32 v133, 64, v132
    s_lshl_b32 s46, s44, 5
    v_add_u32 v133, 113664, v133
    s_add_u32 s46, s46, s45
    v_add_u32 v134, 915456, v132
    s_mul_i32 s35, s46, 7168
    v_add_u32 v135, 915456, v133
    s_mov_b32 s6, 1835008
    s_mov_b32 s7, 0x00020000
    s_lshl_b32 m0, s28, 12
    s_lshl_b32 s36, s42, 7
    s_add_u32 s36, s36, s35
    s_waitcnt lgkmcnt(0)
    buffer_load_dwordx4 v132, s[4:7], s36 offen offset:0 lds
    buffer_load_dwordx4 v133, s[4:7], s36 offen offset:1024 lds
    buffer_load_dwordx4 v134, s[4:7], s36 offen offset:2048 lds
    buffer_load_dwordx4 v135, s[4:7], s36 offen offset:3072 lds
    s_cmp_ge_u32 s28, 4
    s_cbranch_scc1 L_t1
    s_and_b32 s46, s2, 31
    v_bfe_u32 v4, v0, 3, 2
    s_min_u32 s46, s46, 27
    v_bfe_u32 v6, v0, 5, 1
    s_lshl2_add_u32 s46, s46, s28
    v_lshl_add_u32 v4, v6, 3, v4
    s_mul_i32 s46, s46, 224
    v_bfe_u32 v5, v0, 2, 1
    s_add_u32 s46, s46, s3
    v_lshl_add_u32 v4, v4, 1, v5
    s_lshl_b32 s46, s46, 6
    v_and_b32 v5, 3, v0
    s_add_u32 m0, m0, 147456
    v_mul_u32_u24 v4, 448, v4
    s_mov_b32 s26, 1605632
    s_mov_b32 s27, 0x00020000
    v_lshl_add_u32 v4, v5, 4, v4
    s_add_u32 s47, s46, 2560
    s_andn2_b32 s36, 28, s2
    s_cselect_b64 exec, -1, 0
    buffer_load_dwordx4 v4, s[24:27], s46 offen nt lds
    buffer_load_dwordx4 v4, s[24:27], s47 offen offset:1024 nt lds
    s_mov_b64 exec, -1
L_t1:
    s_load_dword s33, s[16:17], 0
    s_load_dwordx2 s[20:21], s[0:1], 56
    s_load_dwordx2 s[8:9], s[0:1], 32
    s_load_dwordx2 s[12:13], s[0:1], 40
    v_bfe_u32 v4, v0, 6, 2
    s_and_b32 s32, s2, 1
    v_bfe_u32 v5, v0, 3, 3
    s_mul_i32 s32, s32, 7
    v_lshl_or_b32 v4, v4, 4, v5
    s_add_u32 s32, s32, s3
    v_lshrrev_b32 v5, 2, v0
    s_bfe_u32 s47, s2, 0x10001
    v_and_b32 v5, 4, v5
    s_lshl1_add_u32 s38, s32, s47
    v_xor_b32 v5, v5, v0
    s_lshl_b32 s38, s38, 7
    v_and_b32 v5, 7, v5
    v_mul_u32_u24 v4, 3584, v4
    s_mov_b32 s10, 1605632
    s_mov_b32 s11, 0x00020000
    v_lshl_add_u32 v21, v5, 4, v4
    s_mov_b32 s14, 1605632
    s_mov_b32 s15, 0x00020000
    v_add_u32 v22, 27648, v21
    v_and_b32 v2, 63, v0
    s_lshl2_add_u32 s31, s44, s45
    v_and_b32 v3, 31, v2
    s_and_b32 s29, s28, 3
    s_lshr_b32 s44, s44, 1
    s_lshl1_add_u32 s0, s45, s44
    s_lshl_b32 s54, s38, 5
    s_add_u32 s54, s54, 32768
    s_lshl_b32 s45, s45, 2
    s_lshr_b32 s39, 0x4206420, s45
    s_lshr_b32 s44, 0x531531, s45
    s_pack_ll_b32_b16 s39, s39, s44
    s_mul_i32 s37, s34, 0x1111111
    s_add_u32 s37, s37, s39
    s_add_u32 s44, s37, 0x1111111
    s_and_b32 s44, s44, 0x8888888
    s_lshr_b32 s44, s44, 3
    s_mul_i32 s44, s44, 7
    s_sub_u32 s37, s37, s44
    s_lshl_b32 s44, s32, 5
    v_lshrrev_b32 v6, 5, v2
    v_add_u32 v5, s44, v3
    s_add_u32 s46, s34, s30
    v_lshrrev_b32 v4, 1, v5
    s_lshl2_add_u32 s46, s46, s29
    v_cvt_f32_u32 v4, v4
    s_lshl_b32 s46, s46, 4
    v_cmp_eq_u32 vcc, 1, v5
    v_mul_f32 v4, 0x3b124925, v4
    v_and_b32 v5, 1, v5
    v_lshl_add_u32 v8, v6, 3, s46
    v_cvt_f32_u32 v5, v5
    v_cvt_f32_u32 v8, v8
    v_mul_f32 v5, 0x3e800000, v5
    s_mov_b64 exec, vcc
    v_mov_b32 v4, 0.5
    v_mov_b32 v5, 0
    s_mov_b64 exec, -1
    v_fma_f32 v8, v8, v4, v5
    v_mul_f32 v7, 0x43000000, v4
    v_cos_f32 v10, v4
    v_fract_f32 v24, v8
    v_fract_f32 v7, v7
    v_lshlrev_b32 v9, 4, v0
    v_add_f32 v10, v10, v10
    v_add_f32 v25, v24, v7
    v_add_f32 v26, v25, v7
    v_add_f32 v27, v26, v7
    v_add_f32 v28, v24, v4
    v_add_f32 v29, v25, v4
    v_add_f32 v30, v26, v4
    v_add_f32 v31, v27, v4
    v_mov_b32 v11, v10
    v_add_u32 v9, 114688, v9
    v_cos_f32 v24, v24
    v_cos_f32 v25, v25
    v_cos_f32 v26, v26
    v_cos_f32 v27, v27
    v_cos_f32 v28, v28
    v_cos_f32 v29, v29
    v_cos_f32 v30, v30
    v_cos_f32 v31, v31
    v_pk_fma_f32 v[32:33], v[10:11], v[28:29], v[24:25] neg_lo:[0,0,1] neg_hi:[0,0,1]
    v_pk_fma_f32 v[34:35], v[10:11], v[30:31], v[26:27] neg_lo:[0,0,1] neg_hi:[0,0,1]
    v_pk_fma_f32 v[36:37], v[10:11], v[32:33], v[28:29] neg_lo:[0,0,1] neg_hi:[0,0,1]
    v_pk_fma_f32 v[38:39], v[10:11], v[34:35], v[30:31] neg_lo:[0,0,1] neg_hi:[0,0,1]
    v_pk_fma_f32 v[40:41], v[10:11], v[36:37], v[32:33] neg_lo:[0,0,1] neg_hi:[0,0,1]
    v_pk_fma_f32 v[42:43], v[10:11], v[38:39], v[34:35] neg_lo:[0,0,1] neg_hi:[0,0,1]
    v_pk_fma_f32 v[44:45], v[10:11], v[40:41], v[36:37] neg_lo:[0,0,1] neg_hi:[0,0,1]
    v_pk_fma_f32 v[46:47], v[10:11], v[42:43], v[38:39] neg_lo:[0,0,1] neg_hi:[0,0,1]
    v_pk_fma_f32 v[48:49], v[10:11], v[44:45], v[40:41] neg_lo:[0,0,1] neg_hi:[0,0,1]
    v_pk_fma_f32 v[50:51], v[10:11], v[46:47], v[42:43] neg_lo:[0,0,1] neg_hi:[0,0,1]
    v_pk_fma_f32 v[52:53], v[10:11], v[48:49], v[44:45] neg_lo:[0,0,1] neg_hi:[0,0,1]
    v_pk_fma_f32 v[54:55], v[10:11], v[50:51], v[46:47] neg_lo:[0,0,1] neg_hi:[0,0,1]
    v_cvt_pk_bf16_f32 v56, v24, v28
    v_cvt_pk_bf16_f32 v57, v32, v36
    v_cvt_pk_bf16_f32 v58, v40, v44
    v_cvt_pk_bf16_f32 v59, v48, v52
    ds_write_b128 v9, v[56:59] offset:0
    v_cvt_pk_bf16_f32 v60, v25, v29
    v_cvt_pk_bf16_f32 v61, v33, v37
    v_cvt_pk_bf16_f32 v62, v41, v45
    v_cvt_pk_bf16_f32 v63, v49, v53
    ds_write_b128 v9, v[60:63] offset:8192
    v_cvt_pk_bf16_f32 v64, v26, v30
    v_cvt_pk_bf16_f32 v65, v34, v38
    v_cvt_pk_bf16_f32 v66, v42, v46
    v_cvt_pk_bf16_f32 v67, v50, v54
    ds_write_b128 v9, v[64:67] offset:16384
    s_cmp_eq_u32 s30, 1
    s_cbranch_scc1 L_t1done
    v_cvt_pk_bf16_f32 v68, v27, v31
    v_cvt_pk_bf16_f32 v69, v35, v39
    v_cvt_pk_bf16_f32 v70, v43, v47
    v_cvt_pk_bf16_f32 v71, v51, v55
    ds_write_b128 v9, v[68:71] offset:24576
L_t1done:
    s_lshl_b32 s34, s29, 12
    v_lshl_add_u32 v4, v3, 7, s34
    s_lshl_b32 s58, s29, 11
    v_bfe_u32 v5, v2, 1, 3
    v_xor_b32 v5, v5, v6
    v_lshl_add_u32 v120, v5, 4, v4
    v_xor_b32 v121, 32, v120
    v_xor_b32 v122, 64, v120
    v_xor_b32 v123, 96, v120
    v_lshlrev_b32 v0, 4, v2
    s_lshl_b32 s41, s28, 11
    s_lshl_b32 s40, s28, 10
    v_bfe_u32 v4, v2, 2, 2
    v_lshlrev_b32 v4, 7, v4
    v_and_b32 v5, 3, v2
    v_lshl_add_u32 v4, v5, 3, v4
    s_mov_b32 s18, 16777216
    s_mov_b32 s19, 0x00020000
    s_mov_b32 s22, 1835008
    s_mov_b32 s23, 0x00020000
    s_lshl_b32 s44, s29, 7
    v_xor_b32 v1, s44, v0
    v_add_u32 v3, 28672, v0
    v_lshl_add_u32 v8, v6, 10, v4
    v_bfe_u32 v7, v2, 3, 1
    v_xor_b32 v7, s30, v7
    v_lshl_add_u32 v8, v7, 6, v8
    v_and_b32 v7, 16, v2
    v_lshl_add_u32 v8, v7, 1, v8
    s_lshr_b32 s45, s29, 1
    s_lshl1_add_u32 s44, s31, s45
    s_lshl2_add_u32 s49, s44, s30
    s_lshl1_add_u32 s50, s44, s30
    s_and_b32 s46, s29, 1
    s_lshl1_add_u32 s49, s49, s46
    s_lshl1_add_u32 s45, s32, s46
    s_lshl_b32 s50, s50, 10
    s_lshl2_add_u32 s50, s45, s50
    s_mul_i32 s49, s49, 14
    s_add_u32 s49, s49, s32
    s_lshl_b32 s49, s49, 11
    s_add_u32 s49, s49, 9437184
    s_add_u32 s50, s50, 524288
    s_and_b32 s44, s2, 7
    s_and_b32 s45, s59, 3
    s_lshl2_add_u32 s43, s44, s45
    s_mul_i32 s42, s29, 7
    s_lshl2_add_u32 s45, s43, s30
    s_mul_i32 s45, s45, 56
    s_add_u32 s45, s45, s42
    s_lshl_b32 s56, s45, 10
    s_add_u32 s56, s56, 9437184
    s_lshl1_add_u32 s45, s43, s30
    s_lshl_b32 s57, s45, 10
    s_andn2_b32 s45, s42, 1
    s_lshl2_add_u32 s57, s45, s57
    s_add_u32 s57, s57, 524288
    s_lshl2_add_u32 s45, s3, s30
    s_mul_i32 s45, s45, 28
    s_add_u32 s45, s45, s42
    s_lshl_b32 s45, s45, 11
    s_add_u32 s55, s45, 7340032
    s_add_u32 s46, s55, 114688
    s_bitcmp1_b32 s43, 3
    s_cselect_b32 s59, s55, s46
    s_cselect_b32 s55, s46, s55
    s_mov_b32 s48, 0x3f803f80
    s_cmp_eq_u32 s30, 1
    s_cbranch_scc1 L_g
    s_add_u32 s44, s34, 147456
    v_and_b32 v7, 48, v2
    v_lshl_add_u32 v7, v7, 1, v4
    v_add_u32 v140, s44, v7
    v_lshl_add_u32 v5, v5, 7, s44
    v_lshl_add_u32 v5, v6, 10, v5
    v_and_b32 v7, 28, v2
    v_lshl_add_u32 v141, v7, 2, v5
    v_add_u32 v143, s44, v0
    s_and_b32 s46, s2, 31
    s_min_u32 s46, s46, 27
    s_and_b32 s44, s46, 1
    s_lshl1_add_u32 s44, s3, s44
    s_lshr_b32 s45, s29, 1
    s_lshl1_add_u32 s44, s44, s45
    s_mul_i32 s44, s44, 28
    s_and_b32 s45, s46, 30
    s_add_u32 s44, s44, s45
    s_and_b32 s45, s29, 1
    s_add_u32 s44, s44, s45
    s_lshl_b32 s44, s44, 11
    s_add_u32 s1, s44, 7340032
    v_bfe_u32 v5, v2, 1, 4
    v_lshlrev_b32 v5, 13, v5
    v_lshl_add_u32 v5, v6, 4, v5
    v_and_b32 v7, 1, v2
    v_lshl_add_u32 v142, v7, 5, v5
    v_add_u32 v124, 114688, v0
    s_lshl_b32 s45, s45, 6
    v_xor_b32 v126, s45, v8
    s_and_b32 s45, s34, 0x2000
    s_add_u32 s45, s45, 0
    v_add_u32 v126, s45, v126
    s_cmp_eq_u32 s0, 7
    s_cselect_b32 s44, 0, s48
    v_mov_b32 v12, s44
    v_mov_b32 v13, s44
    v_mov_b32 v14, s44
    v_mov_b32 v15, s44
    s_lshl2_add_u32 s0, s0, s29
    s_lshl_b32 s0, s0, 7
    s_add_u32 s0, s0, s54
    s_lshl2_add_u32 s45, s31, s29
    s_lshl_b32 s51, s32, 11
    s_add_u32 s51, s51, s45
    s_lshl_b32 s52, s32, 8
    s_add_u32 s52, s52, s45
    s_lshl_b32 s51, s51, 6
    s_add_u32 s51, s51, 1048576
    s_lshl_b32 s52, s52, 2
    s_add_u32 s52, s52, 655360
    s_and_b32 s44, s32, 3
    s_cselect_b32 s53, 0, 0x0
    s_cmp_eq_u32 s32, 0
    s_cselect_b32 s53, 0x43e0, s53
    v_mov_b32 v2, v8
    s_waitcnt lgkmcnt(0)
    s_mul_i32 s33, s33, 0x9E3779B1
    s_add_u32 s33, s33, 0x7F4A7C15
    v_mov_b32 v4, s33
    s_barrier
    s_bfe_u32 s44, s39, 0x30000
    v_lshl_add_u32 v125, s44, 12, v124
    ds_read_b128 v[24:27], v125 offset:0
    ds_read_b128 v[28:31], v125 offset:1024
    ds_read_b128 v[32:35], v125 offset:2048
    ds_read_b128 v[36:39], v125 offset:3072
    s_bfe_u32 s44, s39, 0x30004
    v_lshl_add_u32 v125, s44, 12, v124
    ds_read_b128 v[40:43], v125 offset:0
    ds_read_b128 v[44:47], v125 offset:1024
    ds_read_b128 v[48:51], v125 offset:2048
    ds_read_b128 v[52:55], v125 offset:3072
    s_bfe_u32 s44, s39, 0x30008
    v_lshl_add_u32 v125, s44, 12, v124
    ds_read_b128 v[56:59], v125 offset:0
    ds_read_b128 v[60:63], v125 offset:1024
    ds_read_b128 v[64:67], v125 offset:2048
    ds_read_b128 v[68:71], v125 offset:3072
    s_bfe_u32 s44, s39, 0x3000c
    v_lshl_add_u32 v125, s44, 12, v124
    ds_read_b128 v[72:75], v125 offset:0
    ds_read_b128 v[76:79], v125 offset:1024
    ds_read_b128 v[80:83], v125 offset:2048
    ds_read_b128 v[84:87], v125 offset:3072
    s_bfe_u32 s44, s39, 0x30010
    v_lshl_add_u32 v125, s44, 12, v124
    ds_read_b128 v[104:107], v125 offset:0
    ds_read_b128 v[108:111], v125 offset:1024
    ds_read_b128 v[112:115], v125 offset:2048
    ds_read_b128 v[116:119], v125 offset:3072
    s_waitcnt vmcnt(2) lgkmcnt(0)
    s_barrier
    ds_read_b128 v[144:147], v120 offset:0
    ds_read_b128 v[148:151], v121 offset:0
    ds_read_b128 v[152:155], v122 offset:0
    ds_read_b128 v[156:159], v123 offset:0
    s_add_u32 m0, s34, 32768
    s_bfe_u32 s36, s37, 0x30008
    s_lshl_b32 s36, s36, 7
    s_add_u32 s36, s36, s35
    buffer_load_dwordx4 v132, s[4:7], s36 offen offset:0 lds
    buffer_load_dwordx4 v133, s[4:7], s36 offen offset:1024 lds
    s_waitcnt lgkmcnt(3)
    v_mfma_f32_32x32x16_bf16 v[88:103], v[144:147], v[24:27], 0
    s_bfe_u32 s44, s39, 0x30014
    v_lshl_add_u32 v125, s44, 12, v124
    ds_read_b128 v[24:27], v125 offset:0
    buffer_load_dwordx4 v134, s[4:7], s36 offen offset:2048 lds
    buffer_load_dwordx4 v135, s[4:7], s36 offen offset:3072 lds
    s_waitcnt lgkmcnt(3)
    v_mfma_f32_32x32x16_bf16 v[88:103], v[148:151], v[28:31], v[88:103]
    ds_read_b128 v[28:31], v125 offset:1024
    s_add_u32 m0, s34, 49152
    s_bfe_u32 s36, s37, 0x3000c
    s_lshl_b32 s36, s36, 7
    s_add_u32 s36, s36, s35
    buffer_load_dwordx4 v132, s[4:7], s36 offen offset:0 lds
    s_waitcnt lgkmcnt(3)
    v_mfma_f32_32x32x16_bf16 v[88:103], v[152:155], v[32:35], v[88:103]
    ds_read_b128 v[32:35], v125 offset:2048
    buffer_load_dwordx4 v133, s[4:7], s36 offen offset:1024 lds
    buffer_load_dwordx4 v134, s[4:7], s36 offen offset:2048 lds
    s_waitcnt lgkmcnt(3)
    v_mfma_f32_32x32x16_bf16 v[88:103], v[156:159], v[36:39], v[88:103]
    ds_read_b128 v[36:39], v125 offset:3072
    buffer_load_dwordx4 v135, s[4:7], s36 offen offset:3072 lds
    s_waitcnt lgkmcnt(0)
    s_barrier
    ds_read_b128 v[160:163], v120 offset:16384
    ds_read_b128 v[164:167], v121 offset:16384
    ds_read_b128 v[168:171], v122 offset:16384
    ds_read_b128 v[172:175], v123 offset:16384
    s_add_u32 m0, s34, 65536
    s_bfe_u32 s36, s37, 0x30010
    s_lshl_b32 s36, s36, 7
    s_add_u32 s36, s36, s35
    buffer_load_dwordx4 v132, s[4:7], s36 offen offset:0 lds
    buffer_load_dwordx4 v133, s[4:7], s36 offen offset:1024 lds
    s_waitcnt lgkmcnt(3)
    v_mfma_f32_32x32x16_bf16 v[88:103], v[160:163], v[40:43], v[88:103]
    s_bfe_u32 s44, s39, 0x30018
    v_lshl_add_u32 v125, s44, 12, v124
    ds_read_b128 v[40:43], v125 offset:0
    buffer_load_dwordx4 v134, s[4:7], s36 offen offset:2048 lds
    buffer_load_dwordx4 v135, s[4:7], s36 offen offset:3072 lds
    s_waitcnt lgkmcnt(3)
    v_mfma_f32_32x32x16_bf16 v[88:103], v[164:167], v[44:47], v[88:103]
    ds_read_b128 v[44:47], v125 offset:1024
    s_add_u32 m0, s34, 81920
    s_bfe_u32 s36, s37, 0x30014
    s_lshl_b32 s36, s36, 7
    s_add_u32 s36, s36, s35
    buffer_load_dwordx4 v132, s[4:7], s36 offen offset:0 lds
    s_waitcnt lgkmcnt(3)
    v_mfma_f32_32x32x16_bf16 v[88:103], v[168:171], v[48:51], v[88:103]
    ds_read_b128 v[48:51], v125 offset:2048
    buffer_load_dwordx4 v133, s[4:7], s36 offen offset:1024 lds
    buffer_load_dwordx4 v134, s[4:7], s36 offen offset:2048 lds
    s_waitcnt lgkmcnt(3)
    v_mfma_f32_32x32x16_bf16 v[88:103], v[172:175], v[52:55], v[88:103]
    ds_read_b128 v[52:55], v125 offset:3072
    buffer_load_dwordx4 v135, s[4:7], s36 offen offset:3072 lds
    s_waitcnt vmcnt(8) lgkmcnt(0)
    s_barrier
    ds_read_b128 v[176:179], v120 offset:32768
    ds_read_b128 v[180:183], v121 offset:32768
    ds_read_b128 v[184:187], v122 offset:32768
    ds_read_b128 v[188:191], v123 offset:32768
    ds_read_b128 v[192:195], v120 offset:49152
    ds_read_b128 v[196:199], v121 offset:49152
    ds_read_b128 v[200:203], v122 offset:49152
    ds_read_b128 v[204:207], v123 offset:49152
    s_add_u32 m0, s34, 98304
    s_bfe_u32 s36, s37, 0x30018
    s_lshl_b32 s36, s36, 7
    s_add_u32 s36, s36, s35
    buffer_load_dwordx4 v132, s[4:7], s36 offen offset:0 lds
    buffer_load_dwordx4 v133, s[4:7], s36 offen offset:1024 lds
    s_waitcnt lgkmcnt(7)
    v_mfma_f32_32x32x16_bf16 v[88:103], v[176:179], v[56:59], v[88:103]
    buffer_load_dwordx4 v134, s[4:7], s36 offen offset:2048 lds
    s_waitcnt lgkmcnt(6)
    v_mfma_f32_32x32x16_bf16 v[88:103], v[180:183], v[60:63], v[88:103]
    buffer_load_dwordx4 v135, s[4:7], s36 offen offset:3072 lds
    s_waitcnt lgkmcnt(5)
    v_mfma_f32_32x32x16_bf16 v[88:103], v[184:187], v[64:67], v[88:103]
    s_add_u32 m0, s58, 0
    s_bfe_u32 s36, s37, 0x30000
    s_mul_i32 s36, s36, 229376
    s_add_u32 s36, s36, s38
    buffer_load_dwordx4 v21, s[8:11], s36 offen offset:0 lds
    s_waitcnt lgkmcnt(4)
    v_mfma_f32_32x32x16_bf16 v[88:103], v[188:191], v[68:71], v[88:103]
    s_waitcnt lgkmcnt(3)
    v_mfma_f32_32x32x16_bf16 v[88:103], v[192:195], v[72:75], v[88:103]
    buffer_load_dwordx4 v22, s[8:11], s36 offen offset:1024 lds
    s_add_u32 m0, s58, 8192
    s_waitcnt lgkmcnt(2)
    v_mfma_f32_32x32x16_bf16 v[88:103], v[196:199], v[76:79], v[88:103]
    buffer_load_dwordx4 v21, s[12:15], s36 offen offset:0 lds
    s_waitcnt lgkmcnt(1)
    v_mfma_f32_32x32x16_bf16 v[88:103], v[200:203], v[80:83], v[88:103]
    buffer_load_dwordx4 v22, s[12:15], s36 offen offset:1024 lds
    s_waitcnt lgkmcnt(0)
    v_mfma_f32_32x32x16_bf16 v[88:103], v[204:207], v[84:87], v[88:103]
    s_waitcnt vmcnt(8)
    s_barrier
    v_add_u32 v120, 0x10000, v120
    ds_read_b128 v[208:211], v120 offset:0
    v_add_u32 v121, 0x10000, v121
    ds_read_b128 v[212:215], v121 offset:0
    v_add_u32 v122, 0x10000, v122
    ds_read_b128 v[216:219], v122 offset:0
    v_add_u32 v123, 0x10000, v123
    ds_read_b128 v[220:223], v123 offset:0
    ds_read_b128 v[224:227], v120 offset:16384
    ds_read_b128 v[228:231], v121 offset:16384
    ds_read_b128 v[232:235], v122 offset:16384
    ds_read_b128 v[236:239], v123 offset:16384
    s_waitcnt lgkmcnt(7)
    v_mfma_f32_32x32x16_bf16 v[88:103], v[208:211], v[104:107], v[88:103]
    s_waitcnt lgkmcnt(6)
    v_mfma_f32_32x32x16_bf16 v[88:103], v[212:215], v[108:111], v[88:103]
    s_waitcnt lgkmcnt(5)
    v_mfma_f32_32x32x16_bf16 v[88:103], v[216:219], v[112:115], v[88:103]
    s_waitcnt lgkmcnt(4)
    v_mfma_f32_32x32x16_bf16 v[88:103], v[220:223], v[116:119], v[88:103]
    s_waitcnt lgkmcnt(3)
    v_mfma_f32_32x32x16_bf16 v[88:103], v[224:227], v[24:27], v[88:103]
    s_waitcnt lgkmcnt(2)
    v_mfma_f32_32x32x16_bf16 v[88:103], v[228:231], v[28:31], v[88:103]
    s_waitcnt lgkmcnt(1)
    v_mfma_f32_32x32x16_bf16 v[88:103], v[232:235], v[32:35], v[88:103]
    s_waitcnt lgkmcnt(0)
    v_mfma_f32_32x32x16_bf16 v[88:103], v[236:239], v[36:39], v[88:103]
    s_waitcnt vmcnt(4)
    s_barrier
    ds_read_b128 v[240:243], v120 offset:32768
    ds_read_b128 v[244:247], v121 offset:32768
    ds_read_b128 v[248:251], v122 offset:32768
    ds_read_b128 v[252:255], v123 offset:32768
    s_waitcnt lgkmcnt(3)
    v_mfma_f32_32x32x16_bf16 v[88:103], v[240:243], v[40:43], v[88:103]
    s_waitcnt lgkmcnt(2)
    v_mfma_f32_32x32x16_bf16 v[88:103], v[244:247], v[44:47], v[88:103]
    s_waitcnt lgkmcnt(1)
    v_mfma_f32_32x32x16_bf16 v[88:103], v[248:251], v[48:51], v[88:103]
    s_waitcnt lgkmcnt(0)
    v_mfma_f32_32x32x16_bf16 v[88:103], v[252:255], v[52:55], v[88:103]
    ds_read_b64_tr_b16 v[132:133], v140 offset:0
    ds_read_b64_tr_b16 v[134:135], v140 offset:512
    ds_read_b64_tr_b16 v[136:137], v140 offset:1024
    ds_read_b64_tr_b16 v[138:139], v140 offset:1536
    v_lshrrev_b32 v16, 1, v0
    v_and_b32 v16, 0xf8, v16
    s_lshl_b32 s44, s29, 8
    s_add_u32 s44, s44, 143360
    v_add_u32 v16, s44, v16
    v_lshrrev_b32 v17, 5, v0
    v_and_b32 v17, 16, v17
    s_lshl_b32 s44, s29, 7
    s_add_u32 s44, s44, 144384
    v_add_u32 v17, s44, v17
    s_waitcnt lgkmcnt(0)
    ds_write_b128 v141, v[132:135] offset:2048
    ds_write_b128 v141, v[136:139] offset:2560
    ds_read_b128 v[56:59], v143 offset:2048
    ds_read_b128 v[60:63], v143 offset:3072
    v_mov_b32 v128, 0
    v_mov_b32 v129, 0
    v_mov_b32 v130, 0
    v_mov_b32 v131, 0
    v_writelane_b32 v128, s53, 0
    s_waitcnt lgkmcnt(0)
    s_andn2_b32 s36, 28, s2
    s_cselect_b64 exec, -1, 0
    buffer_store_dwordx4 v[56:59], v0, s[16:19], s1 offen offset:0 sc1
    buffer_store_dwordx4 v[60:63], v0, s[16:19], s1 offen offset:1024 sc1
    s_mov_b64 exec, -1
    s_barrier
    ds_read_b64 v[8:9], v16
    ds_read_b128 v[104:107], v17 offset:0
    ds_read_b128 v[108:111], v17 offset:32
    ds_read_b128 v[112:115], v17 offset:64
    ds_read_b128 v[116:119], v17 offset:96
    s_waitcnt lgkmcnt(4)
    v_rcp_f32 v5, v9
    v_mul_f32 v6, v9, v9
    v_mul_f32 v5, 0xbfb8aa3b, v5
    v_mov_b32 v9, v8
    v_mov_b32 v10, v8
    v_mov_b32 v11, v8
    s_nop 1
    v_mfma_f32_32x32x16_bf16 v[88:103], v[8:11], v[128:131], v[88:103]
    s_waitcnt lgkmcnt(0)
    s_nop 10
    v_mul_f32 v88, v88, v104
    v_mul_f32 v89, v89, v105
    v_mul_f32 v90, v90, v106
    v_mul_f32 v91, v91, v107
    v_mul_f32 v92, v92, v108
    v_mul_f32 v93, v93, v109
    v_mul_f32 v94, v94, v110
    v_mul_f32 v95, v95, v111
    v_fma_f32 v104, v96, v112, v88
    v_fma_f32 v105, v97, v113, v89
    v_fma_f32 v106, v98, v114, v90
    v_fma_f32 v107, v99, v115, v91
    v_fma_f32 v108, v100, v116, v92
    v_fma_f32 v109, v101, v117, v93
    v_fma_f32 v110, v102, v118, v94
    v_fma_f32 v111, v103, v119, v95
    v_cvt_pk_bf16_f32 v104, v104, v105
    v_cvt_pk_bf16_f32 v105, v106, v107
    v_cvt_pk_bf16_f32 v106, v108, v109
    v_cvt_pk_bf16_f32 v107, v110, v111
    buffer_store_dwordx4 v[104:107], v142, s[16:19], s51 offen sc1
    v_fma_f32 v88, -v96, v112, v88
    v_fma_f32 v89, -v97, v113, v89
    v_fma_f32 v90, -v98, v114, v90
    v_fma_f32 v91, -v99, v115, v91
    v_fma_f32 v92, -v100, v116, v92
    v_fma_f32 v93, -v101, v117, v93
    v_fma_f32 v94, -v102, v118, v94
    v_fma_f32 v95, -v103, v119, v95
    s_add_u32 s51, s51, 4096
    v_cvt_pk_bf16_f32 v88, v88, v89
    v_cvt_pk_bf16_f32 v89, v90, v91
    v_cvt_pk_bf16_f32 v90, v92, v93
    v_cvt_pk_bf16_f32 v91, v94, v95
    buffer_store_dwordx4 v[88:91], v142, s[16:19], s51 offen sc1
    s_add_u32 m0, s41, 16384
    s_bfe_u32 s36, s37, 0x30004
    s_mul_i32 s36, s36, 229376
    s_add_u32 s36, s36, s38
    buffer_load_dwordx4 v21, s[8:11], s36 offen offset:0 lds
    buffer_load_dwordx4 v22, s[8:11], s36 offen offset:1024 lds
    s_waitcnt vmcnt(6)
    s_barrier
    ds_read_b64_tr_b16 v[104:105], v126 offset:0
    ds_read_b64_tr_b16 v[106:107], v126 offset:512
    ds_read_b64_tr_b16 v[108:109], v126 offset:2048
    ds_read_b64_tr_b16 v[110:111], v126 offset:2560
    ds_read_b64_tr_b16 v[112:113], v126 offset:4096
    ds_read_b64_tr_b16 v[114:115], v126 offset:4608
    ds_read_b64_tr_b16 v[116:117], v126 offset:6144
    ds_read_b64_tr_b16 v[118:119], v126 offset:6656
    ds_read_b64_tr_b16 v[56:57], v2 offset:0
    ds_read_b64_tr_b16 v[58:59], v2 offset:512
    ds_read_b64_tr_b16 v[60:61], v2 offset:8192
    ds_read_b64_tr_b16 v[62:63], v2 offset:8704
    s_waitcnt lgkmcnt(10)
    v_mfma_f32_32x32x16_bf16 v[88:103], v[12:15], v[104:107], 0
    ds_read_b64_tr_b16 v[64:65], v2 offset:2048
    ds_read_b64_tr_b16 v[66:67], v2 offset:2560
    ds_read_b64_tr_b16 v[68:69], v2 offset:10240
    ds_read_b64_tr_b16 v[70:71], v2 offset:10752
    s_add_u32 m0, s41, 32768
    s_bfe_u32 s36, s37, 0x30008
    s_mul_i32 s36, s36, 229376
    s_add_u32 s36, s36, s38
    buffer_load_dwordx4 v21, s[8:11], s36 offen offset:0 lds
    s_waitcnt lgkmcnt(12)
    v_mfma_f32_32x32x16_bf16 v[88:103], v[12:15], v[108:111], v[88:103]
    ds_read_b64_tr_b16 v[72:73], v2 offset:4096
    ds_read_b64_tr_b16 v[74:75], v2 offset:4608
    ds_read_b64_tr_b16 v[76:77], v2 offset:12288
    ds_read_b64_tr_b16 v[78:79], v2 offset:12800
    buffer_load_dwordx4 v22, s[8:11], s36 offen offset:1024 lds
    s_waitcnt lgkmcnt(14)
    v_mfma_f32_32x32x16_bf16 v[88:103], v[12:15], v[112:115], v[88:103]
    ds_read_b64_tr_b16 v[80:81], v2 offset:6144
    ds_read_b64_tr_b16 v[82:83], v2 offset:6656
    ds_read_b64_tr_b16 v[84:85], v2 offset:14336
    ds_read_b64_tr_b16 v[86:87], v2 offset:14848
    s_waitcnt lgkmcnt(15)
    v_mfma_f32_32x32x16_bf16 v[88:103], v[12:15], v[116:119], v[88:103]
    s_add_u32 m0, s41, 49152
    s_bfe_u32 s36, s37, 0x3000c
    s_mul_i32 s36, s36, 229376
    s_add_u32 s36, s36, s38
    buffer_load_dwordx4 v21, s[8:11], s36 offen offset:0 lds
    s_waitcnt lgkmcnt(12)
    v_mfma_f32_32x32x16_bf16 v[24:39], v[56:59], v[144:147], 0
    buffer_load_dwordx4 v22, s[8:11], s36 offen offset:1024 lds
    v_mfma_f32_32x32x16_bf16 v[40:55], v[60:63], v[144:147], 0
    s_waitcnt lgkmcnt(8)
    v_mfma_f32_32x32x16_bf16 v[24:39], v[64:67], v[148:151], v[24:39]
    s_nop 0
    v_cvt_pk_bf16_f32 v89, v88, v88
    v_lshrrev_b32 v90, 2, v0
    v_and_b32 v89, 0xffff0000, v89
    v_sub_f32 v89, v88, v89
    v_cvt_pk_bf16_f32 v88, v88, v89
    s_mov_b32 exec_hi, 0
    buffer_store_dword v88, v90, s[16:19], s0 offen sc1
    s_mov_b32 exec_hi, -1
    v_mfma_f32_32x32x16_bf16 v[40:55], v[68:71], v[148:151], v[40:55]
    s_waitcnt vmcnt(7)
    s_mov_b64 exec, 1
    buffer_atomic_swap v4, off, s[16:19], s52 offset:0 sc1
    s_mov_b64 exec, -1
    s_branch L_join
L_g:
    v_mov_b32 v128, 0
    v_mov_b32 v129, 0
    v_mov_b32 v130, 0
    v_mov_b32 v131, 0
    v_mov_b32 v2, v8
    s_waitcnt lgkmcnt(0)
    s_mul_i32 s33, s33, 0x9E3779B1
    s_add_u32 s33, s33, 0x7F4A7C15
    v_mov_b32 v4, s33
    s_mov_b64 s[8:9], s[12:13]
    s_barrier
    s_barrier
    ds_read_b128 v[144:147], v120 offset:0
    ds_read_b128 v[148:151], v121 offset:0
    ds_read_b128 v[152:155], v122 offset:0
    ds_read_b128 v[156:159], v123 offset:0
    s_waitcnt lgkmcnt(3)
    v_dot2c_f32_bf16 v128, s48, v144
    v_dot2c_f32_bf16 v130, v144, v144
    v_dot2c_f32_bf16 v129, s48, v145
    v_dot2c_f32_bf16 v131, v145, v145
    v_dot2c_f32_bf16 v128, s48, v146
    v_dot2c_f32_bf16 v130, v146, v146
    v_dot2c_f32_bf16 v129, s48, v147
    v_dot2c_f32_bf16 v131, v147, v147
    s_waitcnt lgkmcnt(2)
    v_dot2c_f32_bf16 v128, s48, v148
    v_dot2c_f32_bf16 v130, v148, v148
    v_dot2c_f32_bf16 v129, s48, v149
    v_dot2c_f32_bf16 v131, v149, v149
    v_dot2c_f32_bf16 v128, s48, v150
    v_dot2c_f32_bf16 v130, v150, v150
    v_dot2c_f32_bf16 v129, s48, v151
    v_dot2c_f32_bf16 v131, v151, v151
    s_waitcnt lgkmcnt(1)
    v_dot2c_f32_bf16 v128, s48, v152
    v_dot2c_f32_bf16 v130, v152, v152
    v_dot2c_f32_bf16 v129, s48, v153
    v_dot2c_f32_bf16 v131, v153, v153
    v_dot2c_f32_bf16 v128, s48, v154
    v_dot2c_f32_bf16 v130, v154, v154
    v_dot2c_f32_bf16 v129, s48, v155
    v_dot2c_f32_bf16 v131, v155, v155
    s_waitcnt lgkmcnt(0)
    v_dot2c_f32_bf16 v128, s48, v156
    v_dot2c_f32_bf16 v130, v156, v156
    v_dot2c_f32_bf16 v129, s48, v157
    v_dot2c_f32_bf16 v131, v157, v157
    v_dot2c_f32_bf16 v128, s48, v158
    v_dot2c_f32_bf16 v130, v158, v158
    v_dot2c_f32_bf16 v129, s48, v159
    v_dot2c_f32_bf16 v131, v159, v159
    s_waitcnt vmcnt(0)
    s_barrier
    ds_read_b128 v[160:163], v120 offset:16384
    ds_read_b128 v[164:167], v121 offset:16384
    ds_read_b128 v[168:171], v122 offset:16384
    ds_read_b128 v[172:175], v123 offset:16384
    s_waitcnt lgkmcnt(3)
    v_dot2c_f32_bf16 v128, s48, v160
    v_dot2c_f32_bf16 v130, v160, v160
    v_dot2c_f32_bf16 v129, s48, v161
    v_dot2c_f32_bf16 v131, v161, v161
    v_dot2c_f32_bf16 v128, s48, v162
    v_dot2c_f32_bf16 v130, v162, v162
    v_dot2c_f32_bf16 v129, s48, v163
    v_dot2c_f32_bf16 v131, v163, v163
    s_waitcnt lgkmcnt(2)
    v_dot2c_f32_bf16 v128, s48, v164
    v_dot2c_f32_bf16 v130, v164, v164
    v_dot2c_f32_bf16 v129, s48, v165
    v_dot2c_f32_bf16 v131, v165, v165
    v_dot2c_f32_bf16 v128, s48, v166
    v_dot2c_f32_bf16 v130, v166, v166
    v_dot2c_f32_bf16 v129, s48, v167
    v_dot2c_f32_bf16 v131, v167, v167
    s_waitcnt lgkmcnt(1)
    v_dot2c_f32_bf16 v128, s48, v168
    v_dot2c_f32_bf16 v130, v168, v168
    v_dot2c_f32_bf16 v129, s48, v169
    v_dot2c_f32_bf16 v131, v169, v169
    v_dot2c_f32_bf16 v128, s48, v170
    v_dot2c_f32_bf16 v130, v170, v170
    v_dot2c_f32_bf16 v129, s48, v171
    v_dot2c_f32_bf16 v131, v171, v171
    s_waitcnt lgkmcnt(0)
    v_dot2c_f32_bf16 v128, s48, v172
    v_dot2c_f32_bf16 v130, v172, v172
    v_dot2c_f32_bf16 v129, s48, v173
    v_dot2c_f32_bf16 v131, v173, v173
    v_dot2c_f32_bf16 v128, s48, v174
    v_dot2c_f32_bf16 v130, v174, v174
    v_dot2c_f32_bf16 v129, s48, v175
    v_dot2c_f32_bf16 v131, v175, v175
    s_barrier
    ds_read_b128 v[176:179], v120 offset:32768
    ds_read_b128 v[180:183], v121 offset:32768
    ds_read_b128 v[184:187], v122 offset:32768
    ds_read_b128 v[188:191], v123 offset:32768
    ds_read_b128 v[192:195], v120 offset:49152
    ds_read_b128 v[196:199], v121 offset:49152
    ds_read_b128 v[200:203], v122 offset:49152
    ds_read_b128 v[204:207], v123 offset:49152
    s_waitcnt lgkmcnt(7)
    v_dot2c_f32_bf16 v128, s48, v176
    v_dot2c_f32_bf16 v130, v176, v176
    v_dot2c_f32_bf16 v129, s48, v177
    v_dot2c_f32_bf16 v131, v177, v177
    v_dot2c_f32_bf16 v128, s48, v178
    v_dot2c_f32_bf16 v130, v178, v178
    v_dot2c_f32_bf16 v129, s48, v179
    v_dot2c_f32_bf16 v131, v179, v179
    s_waitcnt lgkmcnt(6)
    v_dot2c_f32_bf16 v128, s48, v180
    v_dot2c_f32_bf16 v130, v180, v180
    v_dot2c_f32_bf16 v129, s48, v181
    v_dot2c_f32_bf16 v131, v181, v181
    v_dot2c_f32_bf16 v128, s48, v182
    v_dot2c_f32_bf16 v130, v182, v182
    v_dot2c_f32_bf16 v129, s48, v183
    v_dot2c_f32_bf16 v131, v183, v183
    s_waitcnt lgkmcnt(5)
    v_dot2c_f32_bf16 v128, s48, v184
    v_dot2c_f32_bf16 v130, v184, v184
    v_dot2c_f32_bf16 v129, s48, v185
    v_dot2c_f32_bf16 v131, v185, v185
    v_dot2c_f32_bf16 v128, s48, v186
    v_dot2c_f32_bf16 v130, v186, v186
    v_dot2c_f32_bf16 v129, s48, v187
    v_dot2c_f32_bf16 v131, v187, v187
    s_waitcnt lgkmcnt(4)
    v_dot2c_f32_bf16 v128, s48, v188
    v_dot2c_f32_bf16 v130, v188, v188
    v_dot2c_f32_bf16 v129, s48, v189
    v_dot2c_f32_bf16 v131, v189, v189
    v_dot2c_f32_bf16 v128, s48, v190
    v_dot2c_f32_bf16 v130, v190, v190
    v_dot2c_f32_bf16 v129, s48, v191
    v_dot2c_f32_bf16 v131, v191, v191
    s_waitcnt lgkmcnt(0)
    s_barrier
    v_add_u32 v120, 0x10000, v120
    ds_read_b128 v[208:211], v120 offset:0
    v_add_u32 v121, 0x10000, v121
    ds_read_b128 v[212:215], v121 offset:0
    v_add_u32 v122, 0x10000, v122
    ds_read_b128 v[216:219], v122 offset:0
    v_add_u32 v123, 0x10000, v123
    ds_read_b128 v[220:223], v123 offset:0
    ds_read_b128 v[224:227], v120 offset:16384
    ds_read_b128 v[228:231], v121 offset:16384
    ds_read_b128 v[232:235], v122 offset:16384
    ds_read_b128 v[236:239], v123 offset:16384
    v_dot2c_f32_bf16 v128, s48, v192
    v_dot2c_f32_bf16 v130, v192, v192
    v_dot2c_f32_bf16 v129, s48, v193
    v_dot2c_f32_bf16 v131, v193, v193
    v_dot2c_f32_bf16 v128, s48, v194
    v_dot2c_f32_bf16 v130, v194, v194
    v_dot2c_f32_bf16 v129, s48, v195
    v_dot2c_f32_bf16 v131, v195, v195
    v_dot2c_f32_bf16 v128, s48, v196
    v_dot2c_f32_bf16 v130, v196, v196
    v_dot2c_f32_bf16 v129, s48, v197
    v_dot2c_f32_bf16 v131, v197, v197
    v_dot2c_f32_bf16 v128, s48, v198
    v_dot2c_f32_bf16 v130, v198, v198
    v_dot2c_f32_bf16 v129, s48, v199
    v_dot2c_f32_bf16 v131, v199, v199
    s_waitcnt lgkmcnt(0)
    s_barrier
    ds_read_b128 v[240:243], v120 offset:32768
    ds_read_b128 v[244:247], v121 offset:32768
    ds_read_b128 v[248:251], v122 offset:32768
    ds_read_b128 v[252:255], v123 offset:32768
    v_dot2c_f32_bf16 v128, s48, v200
    v_dot2c_f32_bf16 v130, v200, v200
    v_dot2c_f32_bf16 v129, s48, v201
    v_dot2c_f32_bf16 v131, v201, v201
    v_dot2c_f32_bf16 v128, s48, v202
    v_dot2c_f32_bf16 v130, v202, v202
    v_dot2c_f32_bf16 v129, s48, v203
    v_dot2c_f32_bf16 v131, v203, v203
    v_dot2c_f32_bf16 v128, s48, v204
    v_dot2c_f32_bf16 v130, v204, v204
    v_dot2c_f32_bf16 v129, s48, v205
    v_dot2c_f32_bf16 v131, v205, v205
    v_dot2c_f32_bf16 v128, s48, v206
    v_dot2c_f32_bf16 v130, v206, v206
    v_dot2c_f32_bf16 v129, s48, v207
    v_dot2c_f32_bf16 v131, v207, v207
    v_dot2c_f32_bf16 v128, s48, v208
    v_dot2c_f32_bf16 v130, v208, v208
    v_dot2c_f32_bf16 v129, s48, v209
    v_dot2c_f32_bf16 v131, v209, v209
    v_dot2c_f32_bf16 v128, s48, v210
    v_dot2c_f32_bf16 v130, v210, v210
    v_dot2c_f32_bf16 v129, s48, v211
    v_dot2c_f32_bf16 v131, v211, v211
    v_dot2c_f32_bf16 v128, s48, v212
    v_dot2c_f32_bf16 v130, v212, v212
    v_dot2c_f32_bf16 v129, s48, v213
    v_dot2c_f32_bf16 v131, v213, v213
    v_dot2c_f32_bf16 v128, s48, v214
    v_dot2c_f32_bf16 v130, v214, v214
    v_dot2c_f32_bf16 v129, s48, v215
    v_dot2c_f32_bf16 v131, v215, v215
    v_dot2c_f32_bf16 v128, s48, v216
    v_dot2c_f32_bf16 v130, v216, v216
    v_dot2c_f32_bf16 v129, s48, v217
    v_dot2c_f32_bf16 v131, v217, v217
    v_dot2c_f32_bf16 v128, s48, v218
    v_dot2c_f32_bf16 v130, v218, v218
    v_dot2c_f32_bf16 v129, s48, v219
    v_dot2c_f32_bf16 v131, v219, v219
    v_dot2c_f32_bf16 v128, s48, v220
    v_dot2c_f32_bf16 v130, v220, v220
    v_dot2c_f32_bf16 v129, s48, v221
    v_dot2c_f32_bf16 v131, v221, v221
    v_dot2c_f32_bf16 v128, s48, v222
    v_dot2c_f32_bf16 v130, v222, v222
    v_dot2c_f32_bf16 v129, s48, v223
    v_dot2c_f32_bf16 v131, v223, v223
    v_dot2c_f32_bf16 v128, s48, v224
    v_dot2c_f32_bf16 v130, v224, v224
    v_dot2c_f32_bf16 v129, s48, v225
    v_dot2c_f32_bf16 v131, v225, v225
    v_dot2c_f32_bf16 v128, s48, v226
    v_dot2c_f32_bf16 v130, v226, v226
    v_dot2c_f32_bf16 v129, s48, v227
    v_dot2c_f32_bf16 v131, v227, v227
    v_dot2c_f32_bf16 v128, s48, v228
    v_dot2c_f32_bf16 v130, v228, v228
    v_dot2c_f32_bf16 v129, s48, v229
    v_dot2c_f32_bf16 v131, v229, v229
    v_dot2c_f32_bf16 v128, s48, v230
    v_dot2c_f32_bf16 v130, v230, v230
    v_dot2c_f32_bf16 v129, s48, v231
    v_dot2c_f32_bf16 v131, v231, v231
    v_dot2c_f32_bf16 v128, s48, v232
    v_dot2c_f32_bf16 v130, v232, v232
    v_dot2c_f32_bf16 v129, s48, v233
    v_dot2c_f32_bf16 v131, v233, v233
    v_dot2c_f32_bf16 v128, s48, v234
    v_dot2c_f32_bf16 v130, v234, v234
    v_dot2c_f32_bf16 v129, s48, v235
    v_dot2c_f32_bf16 v131, v235, v235
    v_dot2c_f32_bf16 v128, s48, v236
    v_dot2c_f32_bf16 v130, v236, v236
    v_dot2c_f32_bf16 v129, s48, v237
    v_dot2c_f32_bf16 v131, v237, v237
    v_dot2c_f32_bf16 v128, s48, v238
    v_dot2c_f32_bf16 v130, v238, v238
    v_dot2c_f32_bf16 v129, s48, v239
    v_dot2c_f32_bf16 v131, v239, v239
    s_waitcnt lgkmcnt(3)
    v_dot2c_f32_bf16 v128, s48, v240
    v_dot2c_f32_bf16 v130, v240, v240
    v_dot2c_f32_bf16 v129, s48, v241
    v_dot2c_f32_bf16 v131, v241, v241
    v_dot2c_f32_bf16 v128, s48, v242
    v_dot2c_f32_bf16 v130, v242, v242
    v_dot2c_f32_bf16 v129, s48, v243
    v_dot2c_f32_bf16 v131, v243, v243
    s_waitcnt lgkmcnt(2)
    v_dot2c_f32_bf16 v128, s48, v244
    v_dot2c_f32_bf16 v130, v244, v244
    v_dot2c_f32_bf16 v129, s48, v245
    v_dot2c_f32_bf16 v131, v245, v245
    v_dot2c_f32_bf16 v128, s48, v246
    v_dot2c_f32_bf16 v130, v246, v246
    v_dot2c_f32_bf16 v129, s48, v247
    v_dot2c_f32_bf16 v131, v247, v247
    s_waitcnt lgkmcnt(1)
    v_dot2c_f32_bf16 v128, s48, v248
    v_dot2c_f32_bf16 v130, v248, v248
    v_dot2c_f32_bf16 v129, s48, v249
    v_dot2c_f32_bf16 v131, v249, v249
    v_dot2c_f32_bf16 v128, s48, v250
    v_dot2c_f32_bf16 v130, v250, v250
    v_dot2c_f32_bf16 v129, s48, v251
    v_dot2c_f32_bf16 v131, v251, v251
    s_waitcnt lgkmcnt(0)
    v_dot2c_f32_bf16 v128, s48, v252
    v_dot2c_f32_bf16 v130, v252, v252
    v_dot2c_f32_bf16 v129, s48, v253
    v_dot2c_f32_bf16 v131, v253, v253
    v_dot2c_f32_bf16 v128, s48, v254
    v_dot2c_f32_bf16 v130, v254, v254
    v_dot2c_f32_bf16 v129, s48, v255
    v_dot2c_f32_bf16 v131, v255, v255
    s_nop 1
    v_add_f32 v128, v128, v129
    v_add_f32 v130, v130, v131
    v_mov_b32 v129, v128
    v_mov_b32 v131, v130
    v_lshrrev_b32 v12, 1, v0
    v_and_b32 v12, 0xf8, v12
    v_permlane32_swap_b32 v128, v129
    v_permlane32_swap_b32 v130, v131
    v_add_f32 v128, v128, v129
    v_add_f32 v130, v130, v131
    v_mul_f32 v128, 0x3b124925, v128
    v_mul_f32 v130, 0x3b124925, v130
    v_fma_f32 v130, -v128, v128, v130
    v_max_f32 v130, 0, v130
    v_cvt_pk_bf16_f32 v130, v130, v130
    v_and_b32 v130, 0xffff0000, v130
    v_add_f32 v130, 0x3727c5ac, v130
    v_cvt_pk_bf16_f32 v130, v130, v130
    v_and_b32 v130, 0xffff0000, v130
    v_sqrt_f32 v130, v130
    v_cvt_pk_bf16_f32 v8, -v128, -v128
    v_cvt_pk_bf16_f32 v130, v130, v130
    v_and_b32 v9, 0xffff0000, v130
    v_rcp_f32 v5, v9
    s_lshl_b32 s44, s29, 8
    s_add_u32 s44, s44, 143360
    v_add_u32 v12, s44, v12
    ds_write_b64 v12, v[8:9]
    v_lshrrev_b32 v12, 1, v12
    v_add_u32 v12, 0x10000, v12
    ds_write_b32 v12, v5 offset:7168
    v_mul_f32 v6, v9, v9
    v_mul_f32 v5, 0xbfb8aa3b, v5
    v_mov_b32 v9, v8
    v_mov_b32 v10, v8
    v_mov_b32 v11, v8
    s_waitcnt lgkmcnt(0)
    s_barrier
    s_add_u32 m0, s41, 16384
    s_bfe_u32 s36, s37, 0x30004
    s_mul_i32 s36, s36, 229376
    s_add_u32 s36, s36, s38
    buffer_load_dwordx4 v21, s[8:11], s36 offen offset:0 lds
    buffer_load_dwordx4 v22, s[8:11], s36 offen offset:1024 lds
    s_barrier
    ds_read_b64_tr_b16 v[56:57], v2 offset:0
    ds_read_b64_tr_b16 v[58:59], v2 offset:512
    ds_read_b64_tr_b16 v[60:61], v2 offset:8192
    ds_read_b64_tr_b16 v[62:63], v2 offset:8704
    ds_read_b64_tr_b16 v[64:65], v2 offset:2048
    ds_read_b64_tr_b16 v[66:67], v2 offset:2560
    ds_read_b64_tr_b16 v[68:69], v2 offset:10240
    ds_read_b64_tr_b16 v[70:71], v2 offset:10752
    s_waitcnt lgkmcnt(4)
    v_mfma_f32_32x32x16_bf16 v[24:39], v[56:59], v[144:147], 0
    ds_read_b64_tr_b16 v[72:73], v2 offset:4096
    ds_read_b64_tr_b16 v[74:75], v2 offset:4608
    ds_read_b64_tr_b16 v[76:77], v2 offset:12288
    ds_read_b64_tr_b16 v[78:79], v2 offset:12800
    s_add_u32 m0, s41, 32768
    s_bfe_u32 s36, s37, 0x30008
    s_mul_i32 s36, s36, 229376
    s_add_u32 s36, s36, s38
    buffer_load_dwordx4 v21, s[8:11], s36 offen offset:0 lds
    v_mfma_f32_32x32x16_bf16 v[40:55], v[60:63], v[144:147], 0
    ds_read_b64_tr_b16 v[80:81], v2 offset:6144
    ds_read_b64_tr_b16 v[82:83], v2 offset:6656
    ds_read_b64_tr_b16 v[84:85], v2 offset:14336
    ds_read_b64_tr_b16 v[86:87], v2 offset:14848
    buffer_load_dwordx4 v22, s[8:11], s36 offen offset:1024 lds
    s_waitcnt lgkmcnt(8)
    v_mfma_f32_32x32x16_bf16 v[24:39], v[64:67], v[148:151], v[24:39]
    s_add_u32 m0, s41, 49152
    s_bfe_u32 s36, s37, 0x3000c
    s_mul_i32 s36, s36, 229376
    s_add_u32 s36, s36, s38
    buffer_load_dwordx4 v21, s[8:11], s36 offen offset:0 lds
    v_mfma_f32_32x32x16_bf16 v[40:55], v[68:71], v[148:151], v[40:55]
    buffer_load_dwordx4 v22, s[8:11], s36 offen offset:1024 lds
L_join:
    s_waitcnt vmcnt(4) lgkmcnt(0)
    s_barrier
    v_mfma_f32_32x32x16_bf16 v[24:39], v[72:75], v[152:155], v[24:39]
    ds_read_b64_tr_b16 v[56:57], v2 offset:16384
    ds_read_b64_tr_b16 v[58:59], v2 offset:16896
    ds_read_b64_tr_b16 v[60:61], v2 offset:24576
    s_add_u32 m0, s41, 65536
    s_bfe_u32 s36, s37, 0x30010
    s_mul_i32 s36, s36, 229376
    s_add_u32 s36, s36, s38
    buffer_load_dwordx4 v21, s[8:11], s36 offen offset:0 lds
    v_lshrrev_b32 v7, 2, v0
    v_mfma_f32_32x32x16_bf16 v[40:55], v[76:79], v[152:155], v[40:55]
    ds_read_b64_tr_b16 v[62:63], v2 offset:25088
    ds_read_b64_tr_b16 v[64:65], v2 offset:18432
    ds_read_b64_tr_b16 v[66:67], v2 offset:18944
    v_mfma_f32_32x32x16_bf16 v[24:39], v[80:83], v[156:159], v[24:39]
    ds_read_b64_tr_b16 v[68:69], v2 offset:26624
    ds_read_b64_tr_b16 v[70:71], v2 offset:27136
    ds_read_b64_tr_b16 v[72:73], v2 offset:20480
    buffer_load_dwordx4 v22, s[8:11], s36 offen offset:1024 lds
    v_mfma_f32_32x32x16_bf16 v[40:55], v[84:87], v[156:159], v[40:55]
    ds_read_b64_tr_b16 v[74:75], v2 offset:20992
    ds_read_b64_tr_b16 v[76:77], v2 offset:28672
    ds_read_b64_tr_b16 v[78:79], v2 offset:29184
    s_waitcnt lgkmcnt(8)
    v_mfma_f32_32x32x16_bf16 v[24:39], v[56:59], v[160:163], v[24:39]
    ds_read_b64_tr_b16 v[80:81], v2 offset:22528
    ds_read_b64_tr_b16 v[82:83], v2 offset:23040
    s_add_u32 m0, s41, 81920
    s_bfe_u32 s36, s37, 0x30014
    s_mul_i32 s36, s36, 229376
    s_add_u32 s36, s36, s38
    buffer_load_dwordx4 v21, s[8:11], s36 offen offset:0 lds
    v_mfma_f32_32x32x16_bf16 v[40:55], v[60:63], v[160:163], v[40:55]
    ds_read_b64_tr_b16 v[84:85], v2 offset:30720
    ds_read_b64_tr_b16 v[86:87], v2 offset:31232
    s_waitcnt lgkmcnt(8)
    v_mfma_f32_32x32x16_bf16 v[24:39], v[64:67], v[164:167], v[24:39]
    buffer_load_dwordx4 v22, s[8:11], s36 offen offset:1024 lds
    v_mfma_f32_32x32x16_bf16 v[40:55], v[68:71], v[164:167], v[40:55]
    s_waitcnt vmcnt(5) lgkmcnt(0)
    s_barrier
    v_mfma_f32_32x32x16_bf16 v[24:39], v[72:75], v[168:171], v[24:39]
    s_cmp_lg_u32 s28, 0
    s_cbranch_scc1 L_o_1
    s_mul_i32 s44, s3, 896
    s_lshl2_add_u32 s44, s2, s44
    s_add_u32 s44, s44, 671744
    s_mov_b64 exec, 1
    buffer_atomic_swap v4, off, s[16:19], s44 offset:0 sc1
    s_mov_b64 exec, -1
L_o_1:
    ds_read_b64_tr_b16 v[56:57], v2 offset:32768
    ds_read_b64_tr_b16 v[58:59], v2 offset:33280
    ds_read_b64_tr_b16 v[60:61], v2 offset:40960
    s_add_u32 m0, s41, 98304
    s_bfe_u32 s36, s37, 0x30018
    s_mul_i32 s36, s36, 229376
    s_add_u32 s36, s36, s38
    buffer_load_dwordx4 v21, s[8:11], s36 offen offset:0 lds
    v_mfma_f32_32x32x16_bf16 v[40:55], v[76:79], v[168:171], v[40:55]
    ds_read_b64_tr_b16 v[62:63], v2 offset:41472
    ds_read_b64_tr_b16 v[64:65], v2 offset:34816
    ds_read_b64_tr_b16 v[66:67], v2 offset:35328
    v_mfma_f32_32x32x16_bf16 v[24:39], v[80:83], v[172:175], v[24:39]
    ds_read_b64_tr_b16 v[68:69], v2 offset:43008
    ds_read_b64_tr_b16 v[70:71], v2 offset:43520
    ds_read_b64_tr_b16 v[72:73], v2 offset:36864
    buffer_load_dwordx4 v22, s[8:11], s36 offen offset:1024 lds
    v_mfma_f32_32x32x16_bf16 v[40:55], v[84:87], v[172:175], v[40:55]
    ds_read_b64_tr_b16 v[74:75], v2 offset:37376
    ds_read_b64_tr_b16 v[76:77], v2 offset:45056
    ds_read_b64_tr_b16 v[78:79], v2 offset:45568
    s_waitcnt lgkmcnt(8)
    v_mfma_f32_32x32x16_bf16 v[24:39], v[56:59], v[176:179], v[24:39]
    ds_read_b64_tr_b16 v[80:81], v2 offset:38912
    ds_read_b64_tr_b16 v[82:83], v2 offset:39424
    s_add_u32 m0, s41, 147456
    s_bfe_u32 s36, s37, 0x30000
    s_xor_b32 s38, s38, 128
    s_mul_i32 s36, s36, 229376
    s_add_u32 s36, s36, s38
    buffer_load_dwordx4 v21, s[8:11], s36 offen offset:0 lds
    v_mfma_f32_32x32x16_bf16 v[40:55], v[60:63], v[176:179], v[40:55]
    ds_read_b64_tr_b16 v[84:85], v2 offset:47104
    ds_read_b64_tr_b16 v[86:87], v2 offset:47616
    s_waitcnt lgkmcnt(8)
    v_mfma_f32_32x32x16_bf16 v[24:39], v[64:67], v[180:183], v[24:39]
    buffer_load_dwordx4 v22, s[8:11], s36 offen offset:1024 lds
    v_mfma_f32_32x32x16_bf16 v[40:55], v[68:71], v[180:183], v[40:55]
    s_waitcnt vmcnt(8) lgkmcnt(0)
    s_barrier
    v_mfma_f32_32x32x16_bf16 v[24:39], v[72:75], v[184:187], v[24:39]
    ds_read_b64_tr_b16 v[56:57], v2 offset:49152
    ds_read_b64_tr_b16 v[58:59], v2 offset:49664
    ds_read_b64_tr_b16 v[60:61], v2 offset:57344
    s_add_u32 m0, s41, 114688
    s_bfe_u32 s36, s37, 0x30004
    s_mul_i32 s36, s36, 229376
    s_add_u32 s36, s36, s38
    buffer_load_dwordx4 v21, s[8:11], s36 offen offset:0 lds
    v_mfma_f32_32x32x16_bf16 v[40:55], v[76:79], v[184:187], v[40:55]
    ds_read_b64_tr_b16 v[62:63], v2 offset:57856
    ds_read_b64_tr_b16 v[64:65], v2 offset:51200
    ds_read_b64_tr_b16 v[66:67], v2 offset:51712
    v_mfma_f32_32x32x16_bf16 v[24:39], v[80:83], v[188:191], v[24:39]
    ds_read_b64_tr_b16 v[68:69], v2 offset:59392
    ds_read_b64_tr_b16 v[70:71], v2 offset:59904
    ds_read_b64_tr_b16 v[72:73], v2 offset:53248
    buffer_load_dwordx4 v22, s[8:11], s36 offen offset:1024 lds
    v_mfma_f32_32x32x16_bf16 v[40:55], v[84:87], v[188:191], v[40:55]
    ds_read_b64_tr_b16 v[74:75], v2 offset:53760
    ds_read_b64_tr_b16 v[76:77], v2 offset:61440
    ds_read_b64_tr_b16 v[78:79], v2 offset:61952
    s_waitcnt lgkmcnt(8)
    v_mfma_f32_32x32x16_bf16 v[24:39], v[56:59], v[192:195], v[24:39]
    ds_read_b64_tr_b16 v[80:81], v2 offset:55296
    ds_read_b64_tr_b16 v[82:83], v2 offset:55808
    s_add_u32 m0, s41, 131072
    s_bfe_u32 s36, s37, 0x30008
    s_mul_i32 s36, s36, 229376
    s_add_u32 s36, s36, s38
    buffer_load_dwordx4 v21, s[8:11], s36 offen offset:0 lds
    v_mfma_f32_32x32x16_bf16 v[40:55], v[60:63], v[192:195], v[40:55]
    ds_read_b64_tr_b16 v[84:85], v2 offset:63488
    ds_read_b64_tr_b16 v[86:87], v2 offset:64000
    s_waitcnt lgkmcnt(8)
    v_mfma_f32_32x32x16_bf16 v[24:39], v[64:67], v[196:199], v[24:39]
    buffer_load_dwordx4 v22, s[8:11], s36 offen offset:1024 lds
    v_mfma_f32_32x32x16_bf16 v[40:55], v[68:71], v[196:199], v[40:55]
    s_waitcnt vmcnt(10) lgkmcnt(0)
    s_barrier
    v_mfma_f32_32x32x16_bf16 v[24:39], v[72:75], v[200:203], v[24:39]
    s_cmp_lg_u32 s28, 0
    s_cbranch_scc1 L_o_2
    s_lshl_b32 s0, s3, 10
    s_add_u32 s0, s0, 671744
    v_mov_b32 v20, 0
    s_mov_b64 exec, 0xffffffff
    buffer_atomic_or v20, v7, s[16:19], s0 offen sc0 sc1
    s_mov_b64 exec, -1
L_o_2:
    v_add_u32 v2, 0x10000, v2
    ds_read_b64_tr_b16 v[56:57], v2 offset:0
    ds_read_b64_tr_b16 v[58:59], v2 offset:512
    ds_read_b64_tr_b16 v[60:61], v2 offset:8192
    s_add_u32 m0, s41, 0
    s_bfe_u32 s36, s37, 0x3000c
    s_mul_i32 s36, s36, 229376
    s_add_u32 s36, s36, s38
    buffer_load_dwordx4 v21, s[8:11], s36 offen offset:0 lds
    v_mfma_f32_32x32x16_bf16 v[40:55], v[76:79], v[200:203], v[40:55]
    ds_read_b64_tr_b16 v[62:63], v2 offset:8704
    ds_read_b64_tr_b16 v[64:65], v2 offset:2048
    ds_read_b64_tr_b16 v[66:67], v2 offset:2560
    v_mfma_f32_32x32x16_bf16 v[24:39], v[80:83], v[204:207], v[24:39]
    ds_read_b64_tr_b16 v[68:69], v2 offset:10240
    ds_read_b64_tr_b16 v[70:71], v2 offset:10752
    ds_read_b64_tr_b16 v[72:73], v2 offset:4096
    v_mfma_f32_32x32x16_bf16 v[40:55], v[84:87], v[204:207], v[40:55]
    ds_read_b64_tr_b16 v[74:75], v2 offset:4608
    ds_read_b64_tr_b16 v[76:77], v2 offset:12288
    ds_read_b64_tr_b16 v[78:79], v2 offset:12800
    s_waitcnt lgkmcnt(8)
    v_mfma_f32_32x32x16_bf16 v[24:39], v[56:59], v[208:211], v[24:39]
    ds_read_b64_tr_b16 v[80:81], v2 offset:6144
    ds_read_b64_tr_b16 v[82:83], v2 offset:6656
    buffer_load_dwordx4 v22, s[8:11], s36 offen offset:1024 lds
    v_mfma_f32_32x32x16_bf16 v[40:55], v[60:63], v[208:211], v[40:55]
    ds_read_b64_tr_b16 v[84:85], v2 offset:14336
    ds_read_b64_tr_b16 v[86:87], v2 offset:14848
    s_waitcnt lgkmcnt(8)
    v_mfma_f32_32x32x16_bf16 v[24:39], v[64:67], v[212:215], v[24:39]
    v_mfma_f32_32x32x16_bf16 v[40:55], v[68:71], v[212:215], v[40:55]
    s_cmp_lg_u32 s28, 0
    s_cbranch_scc1 L_o_3
    s_mov_b64 exec, 0xffffffff
    s_waitcnt vmcnt(2)
    s_movk_i32 s58, 0x4000
L_pt_4:
    v_cmp_ne_u32 vcc, v4, v20
    s_sub_u32 s58, s58, 1
    s_cbranch_vccz L_po_5
    s_cbranch_scc1 L_po_5
    s_sleep 2
    v_mov_b32 v20, 0
    buffer_atomic_or v20, v7, s[16:19], s0 offen sc0 sc1
    s_waitcnt vmcnt(0)
    s_branch L_pt_4
L_po_5:
    s_mov_b64 exec, -1
L_o_3:
    s_waitcnt vmcnt(10) lgkmcnt(0)
    s_barrier
    v_mfma_f32_32x32x16_bf16 v[24:39], v[72:75], v[216:219], v[24:39]
    ds_read_b64_tr_b16 v[56:57], v2 offset:16384
    ds_read_b64_tr_b16 v[58:59], v2 offset:16896
    ds_read_b64_tr_b16 v[60:61], v2 offset:24576
    s_add_u32 m0, s40, 65536
    s_andn2_b32 s47, s54, 4096
    s_add_u32 s47, s47, s40
    buffer_load_dwordx4 v0, s[16:19], s47 offen sc1 lds
    s_and_b32 s47, s54, 4096
    v_and_b32 v143, 0x200, v0
    s_add_u32 s47, s47, 65536
    v_lshl_add_u32 v143, v143, 2, s47
    s_lshl_b32 s47, s30, 7
    v_bfe_u32 v140, v0, 2, 7
    v_add3_u32 v143, v143, v140, s47
    v_xor_b32 v140, 0x1000, v143
    v_mfma_f32_32x32x16_bf16 v[40:55], v[76:79], v[216:219], v[40:55]
    ds_read_b64_tr_b16 v[62:63], v2 offset:25088
    ds_read_b64_tr_b16 v[64:65], v2 offset:18432
    ds_read_b64_tr_b16 v[66:67], v2 offset:18944
    v_mfma_f32_32x32x16_bf16 v[24:39], v[80:83], v[220:223], v[24:39]
    ds_read_b64_tr_b16 v[68:69], v2 offset:26624
    ds_read_b64_tr_b16 v[70:71], v2 offset:27136
    ds_read_b64_tr_b16 v[72:73], v2 offset:20480
    s_add_u32 m0, s41, 16384
    s_bfe_u32 s36, s37, 0x30010
    s_mul_i32 s36, s36, 229376
    s_add_u32 s36, s36, s38
    buffer_load_dwordx4 v21, s[8:11], s36 offen offset:0 lds
    v_mfma_f32_32x32x16_bf16 v[40:55], v[84:87], v[220:223], v[40:55]
    ds_read_b64_tr_b16 v[74:75], v2 offset:20992
    ds_read_b64_tr_b16 v[76:77], v2 offset:28672
    ds_read_b64_tr_b16 v[78:79], v2 offset:29184
    s_waitcnt lgkmcnt(8)
    v_mfma_f32_32x32x16_bf16 v[24:39], v[56:59], v[224:227], v[24:39]
    ds_read_b64_tr_b16 v[80:81], v2 offset:22528
    ds_read_b64_tr_b16 v[82:83], v2 offset:23040
    v_mfma_f32_32x32x16_bf16 v[40:55], v[60:63], v[224:227], v[40:55]
    ds_read_b64_tr_b16 v[84:85], v2 offset:30720
    ds_read_b64_tr_b16 v[86:87], v2 offset:31232
    buffer_load_dwordx4 v22, s[8:11], s36 offen offset:1024 lds
    s_waitcnt lgkmcnt(8)
    v_mfma_f32_32x32x16_bf16 v[24:39], v[64:67], v[228:231], v[24:39]
    v_mfma_f32_32x32x16_bf16 v[40:55], v[68:71], v[228:231], v[40:55]
    s_waitcnt vmcnt(11) lgkmcnt(0)
    s_barrier
    v_mfma_f32_32x32x16_bf16 v[24:39], v[72:75], v[232:235], v[24:39]
    ds_read_b64_tr_b16 v[56:57], v2 offset:32768
    ds_read_b64_tr_b16 v[58:59], v2 offset:33280
    ds_read_b64_tr_b16 v[60:61], v2 offset:40960
    s_add_u32 m0, s41, 32768
    s_bfe_u32 s36, s37, 0x30014
    s_mul_i32 s36, s36, 229376
    s_add_u32 s36, s36, s38
    buffer_load_dwordx4 v21, s[8:11], s36 offen offset:0 lds
    v_mfma_f32_32x32x16_bf16 v[40:55], v[76:79], v[232:235], v[40:55]
    ds_read_b64_tr_b16 v[62:63], v2 offset:41472
    ds_read_b64_tr_b16 v[64:65], v2 offset:34816
    ds_read_b64_tr_b16 v[66:67], v2 offset:35328
    v_mfma_f32_32x32x16_bf16 v[24:39], v[80:83], v[236:239], v[24:39]
    ds_read_b64_tr_b16 v[68:69], v2 offset:43008
    ds_read_b64_tr_b16 v[70:71], v2 offset:43520
    ds_read_b64_tr_b16 v[72:73], v2 offset:36864
    buffer_load_dwordx4 v22, s[8:11], s36 offen offset:1024 lds
    v_mfma_f32_32x32x16_bf16 v[40:55], v[84:87], v[236:239], v[40:55]
    ds_read_b64_tr_b16 v[74:75], v2 offset:37376
    ds_read_b64_tr_b16 v[76:77], v2 offset:45056
    ds_read_b64_tr_b16 v[78:79], v2 offset:45568
    s_waitcnt lgkmcnt(8)
    v_mfma_f32_32x32x16_bf16 v[24:39], v[56:59], v[240:243], v[24:39]
    ds_read_b64_tr_b16 v[80:81], v2 offset:38912
    ds_read_b64_tr_b16 v[82:83], v2 offset:39424
    s_add_u32 m0, s41, 81920
    s_bfe_u32 s36, s37, 0x30000
    s_lshl_b32 s36, s36, 11
    s_add_u32 s36, s36, s59
    buffer_load_dwordx4 v1, s[16:19], s36 offen offset:0 sc1 lds
    v_mfma_f32_32x32x16_bf16 v[40:55], v[60:63], v[240:243], v[40:55]
    ds_read_b64_tr_b16 v[84:85], v2 offset:47104
    ds_read_b64_tr_b16 v[86:87], v2 offset:47616
    s_waitcnt lgkmcnt(8)
    v_mfma_f32_32x32x16_bf16 v[24:39], v[64:67], v[244:247], v[24:39]
    buffer_load_dwordx4 v1, s[16:19], s36 offen offset:1024 sc1 lds
    v_mfma_f32_32x32x16_bf16 v[40:55], v[68:71], v[244:247], v[40:55]
    s_waitcnt vmcnt(6) lgkmcnt(0)
    s_barrier
    v_mfma_f32_32x32x16_bf16 v[24:39], v[72:75], v[248:251], v[24:39]
    ds_read2st64_b32 v[120:121], v143 offset0:0 offset1:2
    ds_read2st64_b32 v[122:123], v143 offset0:4 offset1:6
    ds_read2st64_b32 v[124:125], v143 offset0:1 offset1:3
    ds_read2st64_b32 v[126:127], v143 offset0:5 offset1:7
    s_add_u32 m0, s41, 49152
    s_bfe_u32 s36, s37, 0x30018
    s_mul_i32 s36, s36, 229376
    s_add_u32 s36, s36, s38
    buffer_load_dwordx4 v21, s[8:11], s36 offen offset:0 lds
    v_mfma_f32_32x32x16_bf16 v[40:55], v[76:79], v[248:251], v[40:55]
    v_add_u32 v2, 0x10000, v2
    ds_read_b64_tr_b16 v[56:57], v2 offset:16384
    ds_read_b64_tr_b16 v[58:59], v2 offset:16896
    ds_read_b64_tr_b16 v[60:61], v2 offset:24576
    v_mfma_f32_32x32x16_bf16 v[24:39], v[80:83], v[252:255], v[24:39]
    ds_read_b64_tr_b16 v[62:63], v2 offset:25088
    ds_read_b64_tr_b16 v[64:65], v2 offset:18432
    ds_read_b64_tr_b16 v[66:67], v2 offset:18944
    buffer_load_dwordx4 v22, s[8:11], s36 offen offset:1024 lds
    v_mfma_f32_32x32x16_bf16 v[40:55], v[84:87], v[252:255], v[40:55]
    ds_read_b64_tr_b16 v[68:69], v2 offset:26624
    ds_read_b64_tr_b16 v[70:71], v2 offset:27136
    ds_read_b64_tr_b16 v[72:73], v2 offset:20480
    s_waitcnt lgkmcnt(9)
    v_mfma_f32_32x32x16_bf16 v[24:39], v[120:123], v[8:11], v[24:39]
    ds_read_b64_tr_b16 v[74:75], v2 offset:20992
    ds_read_b64_tr_b16 v[76:77], v2 offset:28672
    ds_read_b64_tr_b16 v[78:79], v2 offset:29184
    s_add_u32 m0, s41, 98304
    s_bfe_u32 s36, s37, 0x30004
    s_lshl_b32 s36, s36, 11
    s_add_u32 s36, s36, s59
    buffer_load_dwordx4 v1, s[16:19], s36 offen offset:0 sc1 lds
    v_mfma_f32_32x32x16_bf16 v[40:55], v[124:127], v[8:11], v[40:55]
    ds_read_b64_tr_b16 v[80:81], v2 offset:22528
    ds_read_b64_tr_b16 v[82:83], v2 offset:23040
    s_waitcnt lgkmcnt(10)
    v_mfma_f32_32x32x16_bf16 v[88:103], v[56:59], v[144:147], 0
    ds_read_b64_tr_b16 v[84:85], v2 offset:30720
    ds_read_b64_tr_b16 v[86:87], v2 offset:31232
    buffer_load_dwordx4 v1, s[16:19], s36 offen offset:1024 sc1 lds
    v_mfma_f32_32x32x16_bf16 v[104:119], v[60:63], v[144:147], 0
    ds_read2st64_b32 v[132:133], v140 offset0:0 offset1:2
    ds_read2st64_b32 v[134:135], v140 offset0:4 offset1:6
    ds_read2st64_b32 v[136:137], v140 offset0:1 offset1:3
    ds_read2st64_b32 v[138:139], v140 offset0:5 offset1:7
    s_waitcnt lgkmcnt(12)
    v_mfma_f32_32x32x16_bf16 v[88:103], v[64:67], v[148:151], v[88:103]
    v_mfma_f32_32x32x16_bf16 v[104:119], v[68:71], v[148:151], v[104:119]
    s_waitcnt lgkmcnt(0)
    s_barrier
    v_mfma_f32_32x32x16_bf16 v[88:103], v[72:75], v[152:155], v[88:103]
    v_subrev_u32 v2, 0x10000, v2
    ds_read_b64_tr_b16 v[56:57], v2 offset:49152
    ds_read_b64_tr_b16 v[58:59], v2 offset:49664
    ds_read_b64_tr_b16 v[60:61], v2 offset:57344
    s_add_u32 m0, s41, 147456
    s_bfe_u32 s36, s37, 0x30008
    s_lshl_b32 s36, s36, 11
    s_add_u32 s36, s36, s59
    buffer_load_dwordx4 v1, s[16:19], s36 offen offset:0 sc1 lds
    v_mul_f32 v12, v24, v5
    v_mul_f32 v13, v25, v5
    v_exp_f32 v12, v12
    v_mul_f32 v40, v24, v40
    v_mfma_f32_32x32x16_bf16 v[104:119], v[76:79], v[152:155], v[104:119]
    ds_read_b64_tr_b16 v[62:63], v2 offset:57856
    ds_read_b64_tr_b16 v[64:65], v2 offset:51200
    ds_read_b64_tr_b16 v[66:67], v2 offset:51712
    v_exp_f32 v13, v13
    v_mul_f32 v41, v25, v41
    v_fma_f32 v12, v12, v6, v6
    v_fma_f32 v13, v13, v6, v6
    v_mfma_f32_32x32x16_bf16 v[88:103], v[80:83], v[156:159], v[88:103]
    ds_read_b64_tr_b16 v[68:69], v2 offset:59392
    ds_read_b64_tr_b16 v[70:71], v2 offset:59904
    ds_read_b64_tr_b16 v[72:73], v2 offset:53248
    buffer_load_dwordx4 v1, s[16:19], s36 offen offset:1024 sc1 lds
    v_rcp_f32 v12, v12
    v_rcp_f32 v13, v13
    v_mul_f32 v14, v26, v5
    v_mfma_f32_32x32x16_bf16 v[104:119], v[84:87], v[156:159], v[104:119]
    ds_read_b64_tr_b16 v[74:75], v2 offset:53760
    ds_read_b64_tr_b16 v[76:77], v2 offset:61440
    ds_read_b64_tr_b16 v[78:79], v2 offset:61952
    v_mul_f32 v15, v27, v5
    v_exp_f32 v14, v14
    v_mul_f32 v42, v26, v42
    s_waitcnt lgkmcnt(8)
    v_mfma_f32_32x32x16_bf16 v[88:103], v[56:59], v[160:163], v[88:103]
    ds_read_b64_tr_b16 v[80:81], v2 offset:55296
    ds_read_b64_tr_b16 v[82:83], v2 offset:55808
    s_add_u32 m0, s41, 65536
    s_bfe_u32 s36, s37, 0x3000c
    s_lshl_b32 s36, s36, 11
    s_add_u32 s36, s36, s59
    buffer_load_dwordx4 v1, s[16:19], s36 offen offset:0 sc1 lds
    v_exp_f32 v15, v15
    v_mul_f32 v43, v27, v43
    v_mul_f32 v40, v40, v12
    v_mul_f32 v41, v41, v13
    v_mfma_f32_32x32x16_bf16 v[104:119], v[60:63], v[160:163], v[104:119]
    ds_read_b64_tr_b16 v[84:85], v2 offset:63488
    ds_read_b64_tr_b16 v[86:87], v2 offset:64000
    v_cvt_pk_bf16_f32 v24, v40, v41
    v_fma_f32 v14, v14, v6, v6
    v_fma_f32 v15, v15, v6, v6
    v_rcp_f32 v14, v14
    s_waitcnt lgkmcnt(8)
    v_mfma_f32_32x32x16_bf16 v[88:103], v[64:67], v[164:167], v[88:103]
    buffer_load_dwordx4 v1, s[16:19], s36 offen offset:1024 sc1 lds
    v_rcp_f32 v15, v15
    v_mul_f32 v12, v28, v5
    v_mul_f32 v13, v29, v5
    v_mfma_f32_32x32x16_bf16 v[104:119], v[68:71], v[164:167], v[104:119]
    v_exp_f32 v12, v12
    v_mul_f32 v44, v28, v44
    v_exp_f32 v13, v13
    s_waitcnt lgkmcnt(0)
    s_barrier
    v_mfma_f32_32x32x16_bf16 v[88:103], v[72:75], v[168:171], v[88:103]
    v_add_u32 v2, 0x10000, v2
    ds_read_b64_tr_b16 v[56:57], v2 offset:0
    ds_read_b64_tr_b16 v[58:59], v2 offset:512
    ds_read_b64_tr_b16 v[60:61], v2 offset:8192
    s_add_u32 m0, s41, 114688
    s_bfe_u32 s36, s37, 0x30010
    s_lshl_b32 s36, s36, 11
    s_add_u32 s36, s36, s59
    buffer_load_dwordx4 v1, s[16:19], s36 offen offset:0 sc1 lds
    v_mul_f32 v45, v29, v45
    v_mul_f32 v42, v42, v14
    v_mul_f32 v43, v43, v15
    v_cvt_pk_bf16_f32 v25, v42, v43
    v_fma_f32 v12, v12, v6, v6
    v_mfma_f32_32x32x16_bf16 v[104:119], v[76:79], v[168:171], v[104:119]
    ds_read_b64_tr_b16 v[62:63], v2 offset:8704
    ds_read_b64_tr_b16 v[64:65], v2 offset:2048
    ds_read_b64_tr_b16 v[66:67], v2 offset:2560
    v_fma_f32 v13, v13, v6, v6
    v_rcp_f32 v12, v12
    v_rcp_f32 v13, v13
    v_mfma_f32_32x32x16_bf16 v[88:103], v[80:83], v[172:175], v[88:103]
    ds_read_b64_tr_b16 v[68:69], v2 offset:10240
    ds_read_b64_tr_b16 v[70:71], v2 offset:10752
    ds_read_b64_tr_b16 v[72:73], v2 offset:4096
    buffer_load_dwordx4 v1, s[16:19], s36 offen offset:1024 sc1 lds
    v_mul_f32 v14, v30, v5
    v_mul_f32 v15, v31, v5
    v_exp_f32 v14, v14
    v_mul_f32 v46, v30, v46
    v_mfma_f32_32x32x16_bf16 v[104:119], v[84:87], v[172:175], v[104:119]
    ds_read_b64_tr_b16 v[74:75], v2 offset:4608
    ds_read_b64_tr_b16 v[76:77], v2 offset:12288
    ds_read_b64_tr_b16 v[78:79], v2 offset:12800
    v_exp_f32 v15, v15
    v_mul_f32 v47, v31, v47
    v_mul_f32 v44, v44, v12
    v_mul_f32 v45, v45, v13
    s_waitcnt lgkmcnt(8)
    v_mfma_f32_32x32x16_bf16 v[88:103], v[56:59], v[176:179], v[88:103]
    ds_read_b64_tr_b16 v[80:81], v2 offset:6144
    ds_read_b64_tr_b16 v[82:83], v2 offset:6656
    s_bfe_u32 s36, s37, 0x30000
    s_lshl_b32 s36, s36, 11
    s_add_u32 s36, s36, s55
    buffer_load_dwordx4 v[144:147], v1, s[16:19], s36 offen offset:0 sc1
    v_cvt_pk_bf16_f32 v26, v44, v45
    v_fma_f32 v14, v14, v6, v6
    v_fma_f32 v15, v15, v6, v6
    v_rcp_f32 v14, v14
    v_mfma_f32_32x32x16_bf16 v[104:119], v[60:63], v[176:179], v[104:119]
    ds_read_b64_tr_b16 v[84:85], v2 offset:14336
    ds_read_b64_tr_b16 v[86:87], v2 offset:14848
    v_rcp_f32 v15, v15
    v_mul_f32 v12, v32, v5
    v_mul_f32 v13, v33, v5
    s_waitcnt lgkmcnt(8)
    v_mfma_f32_32x32x16_bf16 v[88:103], v[64:67], v[180:183], v[88:103]
    buffer_load_dwordx4 v[148:151], v1, s[16:19], s36 offen offset:1024 sc1
    v_exp_f32 v12, v12
    v_mul_f32 v48, v32, v48
    v_exp_f32 v13, v13
    v_mfma_f32_32x32x16_bf16 v[104:119], v[68:71], v[180:183], v[104:119]
    v_mul_f32 v49, v33, v49
    v_mul_f32 v46, v46, v14
    v_mul_f32 v47, v47, v15
    v_cvt_pk_bf16_f32 v27, v46, v47
    buffer_store_dwordx4 v[24:27], v0, s[16:19], s49 offen offset:0 sc1
    s_waitcnt lgkmcnt(0)
    s_barrier
    v_mfma_f32_32x32x16_bf16 v[88:103], v[72:75], v[184:187], v[88:103]
    v_subrev_u32 v2, 0x20000, v2
    ds_read_b64_tr_b16 v[56:57], v2 offset:0
    ds_read_b64_tr_b16 v[58:59], v2 offset:512
    ds_read_b64_tr_b16 v[60:61], v2 offset:8192
    s_add_u32 m0, s41, 131072
    s_bfe_u32 s36, s37, 0x30014
    s_lshl_b32 s36, s36, 11
    s_add_u32 s36, s36, s59
    buffer_load_dwordx4 v1, s[16:19], s36 offen offset:0 sc1 lds
    v_fma_f32 v12, v12, v6, v6
    v_fma_f32 v13, v13, v6, v6
    v_rcp_f32 v12, v12
    v_mfma_f32_32x32x16_bf16 v[104:119], v[76:79], v[184:187], v[104:119]
    ds_read_b64_tr_b16 v[62:63], v2 offset:8704
    ds_read_b64_tr_b16 v[64:65], v2 offset:2048
    ds_read_b64_tr_b16 v[66:67], v2 offset:2560
    v_rcp_f32 v13, v13
    v_mul_f32 v14, v34, v5
    v_mul_f32 v15, v35, v5
    v_mfma_f32_32x32x16_bf16 v[88:103], v[80:83], v[188:191], v[88:103]
    ds_read_b64_tr_b16 v[68:69], v2 offset:10240
    ds_read_b64_tr_b16 v[70:71], v2 offset:10752
    ds_read_b64_tr_b16 v[72:73], v2 offset:4096
    buffer_load_dwordx4 v1, s[16:19], s36 offen offset:1024 sc1 lds
    v_exp_f32 v14, v14
    v_mul_f32 v50, v34, v50
    v_exp_f32 v15, v15
    v_mfma_f32_32x32x16_bf16 v[104:119], v[84:87], v[188:191], v[104:119]
    ds_read_b64_tr_b16 v[74:75], v2 offset:4608
    ds_read_b64_tr_b16 v[76:77], v2 offset:12288
    ds_read_b64_tr_b16 v[78:79], v2 offset:12800
    v_mul_f32 v51, v35, v51
    v_mul_f32 v48, v48, v12
    v_mul_f32 v49, v49, v13
    v_cvt_pk_bf16_f32 v28, v48, v49
    v_fma_f32 v14, v14, v6, v6
    s_waitcnt lgkmcnt(8)
    v_mfma_f32_32x32x16_bf16 v[88:103], v[56:59], v[192:195], v[88:103]
    ds_read_b64_tr_b16 v[80:81], v2 offset:6144
    ds_read_b64_tr_b16 v[82:83], v2 offset:6656
    s_bfe_u32 s36, s37, 0x30004
    s_lshl_b32 s36, s36, 11
    s_add_u32 s36, s36, s55
    buffer_load_dwordx4 v[152:155], v1, s[16:19], s36 offen offset:0 sc1
    v_fma_f32 v15, v15, v6, v6
    v_rcp_f32 v14, v14
    v_rcp_f32 v15, v15
    v_mfma_f32_32x32x16_bf16 v[104:119], v[60:63], v[192:195], v[104:119]
    ds_read_b64_tr_b16 v[84:85], v2 offset:14336
    ds_read_b64_tr_b16 v[86:87], v2 offset:14848
    v_mul_f32 v12, v36, v5
    v_mul_f32 v13, v37, v5
    v_exp_f32 v12, v12
    v_mul_f32 v52, v36, v52
    s_waitcnt lgkmcnt(8)
    v_mfma_f32_32x32x16_bf16 v[88:103], v[64:67], v[196:199], v[88:103]
    buffer_load_dwordx4 v[156:159], v1, s[16:19], s36 offen offset:1024 sc1
    v_exp_f32 v13, v13
    v_mul_f32 v53, v37, v53
    v_mul_f32 v50, v50, v14
    v_mul_f32 v51, v51, v15
    v_mfma_f32_32x32x16_bf16 v[104:119], v[68:71], v[196:199], v[104:119]
    v_cvt_pk_bf16_f32 v29, v50, v51
    v_fma_f32 v12, v12, v6, v6
    v_fma_f32 v13, v13, v6, v6
    v_rcp_f32 v12, v12
    s_waitcnt vmcnt(21) lgkmcnt(0)
    s_barrier
    v_mfma_f32_32x32x16_bf16 v[88:103], v[72:75], v[200:203], v[88:103]
    ds_read_b64_tr_b16 v[56:57], v2 offset:16384
    ds_read_b64_tr_b16 v[58:59], v2 offset:16896
    ds_read_b64_tr_b16 v[60:61], v2 offset:24576
    s_add_u32 m0, s41, 0
    s_bfe_u32 s36, s37, 0x30018
    s_lshl_b32 s36, s36, 11
    s_add_u32 s36, s36, s59
    buffer_load_dwordx4 v1, s[16:19], s36 offen offset:0 sc1 lds
    v_rcp_f32 v13, v13
    v_mul_f32 v14, v38, v5
    v_mul_f32 v15, v39, v5
    v_mfma_f32_32x32x16_bf16 v[104:119], v[76:79], v[200:203], v[104:119]
    ds_read_b64_tr_b16 v[62:63], v2 offset:25088
    ds_read_b64_tr_b16 v[64:65], v2 offset:18432
    ds_read_b64_tr_b16 v[66:67], v2 offset:18944
    v_exp_f32 v14, v14
    v_mul_f32 v54, v38, v54
    v_exp_f32 v15, v15
    v_mfma_f32_32x32x16_bf16 v[88:103], v[80:83], v[204:207], v[88:103]
    ds_read_b64_tr_b16 v[68:69], v2 offset:26624
    ds_read_b64_tr_b16 v[70:71], v2 offset:27136
    ds_read_b64_tr_b16 v[72:73], v2 offset:20480
    buffer_load_dwordx4 v1, s[16:19], s36 offen offset:1024 sc1 lds
    v_mul_f32 v55, v39, v55
    v_mul_f32 v52, v52, v12
    v_mul_f32 v53, v53, v13
    v_cvt_pk_bf16_f32 v30, v52, v53
    v_fma_f32 v14, v14, v6, v6
    v_mfma_f32_32x32x16_bf16 v[104:119], v[84:87], v[204:207], v[104:119]
    ds_read_b64_tr_b16 v[74:75], v2 offset:20992
    ds_read_b64_tr_b16 v[76:77], v2 offset:28672
    ds_read_b64_tr_b16 v[78:79], v2 offset:29184
    v_fma_f32 v15, v15, v6, v6
    v_rcp_f32 v14, v14
    v_rcp_f32 v15, v15
    s_waitcnt lgkmcnt(8)
    v_mfma_f32_32x32x16_bf16 v[88:103], v[56:59], v[208:211], v[88:103]
    ds_read_b64_tr_b16 v[80:81], v2 offset:22528
    ds_read_b64_tr_b16 v[82:83], v2 offset:23040
    s_bfe_u32 s36, s37, 0x30008
    s_lshl_b32 s36, s36, 11
    s_add_u32 s36, s36, s55
    buffer_load_dwordx4 v[160:163], v1, s[16:19], s36 offen offset:0 sc1
    v_mul_f32 v54, v54, v14
    v_mul_f32 v55, v55, v15
    v_cvt_pk_bf16_f32 v31, v54, v55
    buffer_store_dwordx4 v[28:31], v0, s[16:19], s49 offen offset:1024 sc1
    v_mfma_f32_32x32x16_bf16 v[104:119], v[60:63], v[208:211], v[104:119]
    ds_read_b64_tr_b16 v[84:85], v2 offset:30720
    ds_read_b64_tr_b16 v[86:87], v2 offset:31232
    s_waitcnt lgkmcnt(8)
    v_mfma_f32_32x32x16_bf16 v[88:103], v[64:67], v[212:215], v[88:103]
    buffer_load_dwordx4 v[164:167], v1, s[16:19], s36 offen offset:1024 sc1
    v_mfma_f32_32x32x16_bf16 v[104:119], v[68:71], v[212:215], v[104:119]
    s_waitcnt vmcnt(20) lgkmcnt(0)
    s_barrier
    v_mfma_f32_32x32x16_bf16 v[88:103], v[72:75], v[216:219], v[88:103]
    ds_read_b64_tr_b16 v[56:57], v2 offset:32768
    ds_read_b64_tr_b16 v[58:59], v2 offset:33280
    ds_read_b64_tr_b16 v[60:61], v2 offset:40960
    s_bfe_u32 s36, s37, 0x3000c
    s_lshl_b32 s36, s36, 11
    s_add_u32 s36, s36, s55
    buffer_load_dwordx4 v[168:171], v1, s[16:19], s36 offen offset:0 sc1
    s_waitcnt vmcnt(2)
    s_mov_b64 exec, 1
    buffer_atomic_swap v4, off, s[16:19], s50 offset:0 sc1
    s_mov_b64 exec, -1
    v_mfma_f32_32x32x16_bf16 v[104:119], v[76:79], v[216:219], v[104:119]
    ds_read_b64_tr_b16 v[62:63], v2 offset:41472
    ds_read_b64_tr_b16 v[64:65], v2 offset:34816
    ds_read_b64_tr_b16 v[66:67], v2 offset:35328
    v_mfma_f32_32x32x16_bf16 v[88:103], v[80:83], v[220:223], v[88:103]
    ds_read_b64_tr_b16 v[68:69], v2 offset:43008
    ds_read_b64_tr_b16 v[70:71], v2 offset:43520
    ds_read_b64_tr_b16 v[72:73], v2 offset:36864
    buffer_load_dwordx4 v[172:175], v1, s[16:19], s36 offen offset:1024 sc1
    v_mfma_f32_32x32x16_bf16 v[104:119], v[84:87], v[220:223], v[104:119]
    ds_read_b64_tr_b16 v[74:75], v2 offset:37376
    ds_read_b64_tr_b16 v[76:77], v2 offset:45056
    ds_read_b64_tr_b16 v[78:79], v2 offset:45568
    s_waitcnt lgkmcnt(8)
    v_mfma_f32_32x32x16_bf16 v[88:103], v[56:59], v[224:227], v[88:103]
    ds_read_b64_tr_b16 v[80:81], v2 offset:38912
    ds_read_b64_tr_b16 v[82:83], v2 offset:39424
    s_bfe_u32 s36, s37, 0x30010
    s_lshl_b32 s36, s36, 11
    s_add_u32 s36, s36, s55
    buffer_load_dwordx4 v[176:179], v1, s[16:19], s36 offen offset:0 sc1
    v_mfma_f32_32x32x16_bf16 v[104:119], v[60:63], v[224:227], v[104:119]
    ds_read_b64_tr_b16 v[84:85], v2 offset:47104
    ds_read_b64_tr_b16 v[86:87], v2 offset:47616
    s_waitcnt lgkmcnt(8)
    v_mfma_f32_32x32x16_bf16 v[88:103], v[64:67], v[228:231], v[88:103]
    buffer_load_dwordx4 v[180:183], v1, s[16:19], s36 offen offset:1024 sc1
    v_mfma_f32_32x32x16_bf16 v[104:119], v[68:71], v[228:231], v[104:119]
    s_waitcnt lgkmcnt(4)
    v_mfma_f32_32x32x16_bf16 v[88:103], v[72:75], v[232:235], v[88:103]
    ds_read_b64_tr_b16 v[56:57], v2 offset:49152
    ds_read_b64_tr_b16 v[58:59], v2 offset:49664
    ds_read_b64_tr_b16 v[60:61], v2 offset:57344
    s_bfe_u32 s36, s37, 0x30014
    s_lshl_b32 s36, s36, 11
    s_add_u32 s36, s36, s55
    buffer_load_dwordx4 v[184:187], v1, s[16:19], s36 offen offset:0 sc1
    v_mov_b32 v20, 0
    s_mov_b64 exec, 0xff
    buffer_atomic_or v20, v7, s[16:19], s57 offen sc0 sc1
    s_mov_b64 exec, -1
    v_mfma_f32_32x32x16_bf16 v[104:119], v[76:79], v[232:235], v[104:119]
    ds_read_b64_tr_b16 v[62:63], v2 offset:57856
    ds_read_b64_tr_b16 v[64:65], v2 offset:51200
    ds_read_b64_tr_b16 v[66:67], v2 offset:51712
    s_waitcnt lgkmcnt(6)
    v_mfma_f32_32x32x16_bf16 v[88:103], v[80:83], v[236:239], v[88:103]
    ds_read_b64_tr_b16 v[68:69], v2 offset:59392
    ds_read_b64_tr_b16 v[70:71], v2 offset:59904
    ds_read_b64_tr_b16 v[72:73], v2 offset:53248
    buffer_load_dwordx4 v[188:191], v1, s[16:19], s36 offen offset:1024 sc1
    v_mfma_f32_32x32x16_bf16 v[104:119], v[84:87], v[236:239], v[104:119]
    ds_read_b64_tr_b16 v[74:75], v2 offset:53760
    ds_read_b64_tr_b16 v[76:77], v2 offset:61440
    ds_read_b64_tr_b16 v[78:79], v2 offset:61952
    s_waitcnt lgkmcnt(8)
    v_mfma_f32_32x32x16_bf16 v[88:103], v[56:59], v[240:243], v[88:103]
    ds_read_b64_tr_b16 v[80:81], v2 offset:55296
    ds_read_b64_tr_b16 v[82:83], v2 offset:55808
    s_bfe_u32 s36, s37, 0x30018
    s_lshl_b32 s36, s36, 11
    s_add_u32 s36, s36, s55
    buffer_load_dwordx4 v[192:195], v1, s[16:19], s36 offen offset:0 sc1
    v_mfma_f32_32x32x16_bf16 v[104:119], v[60:63], v[240:243], v[104:119]
    ds_read_b64_tr_b16 v[84:85], v2 offset:63488
    ds_read_b64_tr_b16 v[86:87], v2 offset:64000
    s_waitcnt lgkmcnt(8)
    v_mfma_f32_32x32x16_bf16 v[88:103], v[64:67], v[244:247], v[88:103]
    buffer_load_dwordx4 v[196:199], v1, s[16:19], s36 offen offset:1024 sc1
    v_mfma_f32_32x32x16_bf16 v[104:119], v[68:71], v[244:247], v[104:119]
    s_waitcnt lgkmcnt(4)
    v_mfma_f32_32x32x16_bf16 v[88:103], v[72:75], v[248:251], v[88:103]
    v_mfma_f32_32x32x16_bf16 v[104:119], v[76:79], v[248:251], v[104:119]
    s_waitcnt lgkmcnt(0)
    v_mfma_f32_32x32x16_bf16 v[88:103], v[80:83], v[252:255], v[88:103]
    v_mfma_f32_32x32x16_bf16 v[104:119], v[84:87], v[252:255], v[104:119]
    s_mov_b64 exec, 0xff
    s_waitcnt vmcnt(3)
    s_movk_i32 s58, 0x4000
L_pt_6:
    v_cmp_ne_u32 vcc, v4, v20
    s_sub_u32 s58, s58, 1
    s_cbranch_vccz L_po_7
    s_cbranch_scc1 L_po_7
    s_sleep 2
    v_mov_b32 v20, 0
    buffer_atomic_or v20, v7, s[16:19], s57 offen sc0 sc1
    s_waitcnt vmcnt(0)
    s_branch L_pt_6
L_po_7:
    s_mov_b64 exec, -1
    v_mfma_f32_32x32x16_bf16 v[88:103], v[132:135], v[8:11], v[88:103]
    s_bfe_u32 s36, s37, 0x30000
    s_lshl_b32 s36, s36, 10
    s_add_u32 s36, s36, s56
    buffer_load_dwordx4 v[200:203], v0, s[16:19], s36 offen sc1
    buffer_load_dwordx4 v[204:207], v3, s[16:19], s36 offen sc1
    s_bfe_u32 s36, s37, 0x30004
    s_lshl_b32 s36, s36, 10
    s_add_u32 s36, s36, s56
    buffer_load_dwordx4 v[208:211], v0, s[16:19], s36 offen sc1
    buffer_load_dwordx4 v[212:215], v3, s[16:19], s36 offen sc1
    s_bfe_u32 s36, s37, 0x30008
    s_lshl_b32 s36, s36, 10
    s_add_u32 s36, s36, s56
    buffer_load_dwordx4 v[216:219], v0, s[16:19], s36 offen sc1
    buffer_load_dwordx4 v[220:223], v3, s[16:19], s36 offen sc1
    v_mfma_f32_32x32x16_bf16 v[104:119], v[136:139], v[8:11], v[104:119]
    s_add_u32 s49, s49, 114688
    v_mul_f32 v12, v88, v5
    v_mul_f32 v13, v89, v5
    v_exp_f32 v12, v12
    s_nop 7
    v_mul_f32 v104, v88, v104
    v_exp_f32 v13, v13
    v_mul_f32 v105, v89, v105
    v_fma_f32 v12, v12, v6, v6
    v_fma_f32 v13, v13, v6, v6
    v_rcp_f32 v12, v12
    v_rcp_f32 v13, v13
    v_mul_f32 v14, v90, v5
    v_mul_f32 v15, v91, v5
    v_exp_f32 v14, v14
    v_mul_f32 v106, v90, v106
    v_exp_f32 v15, v15
    v_mul_f32 v107, v91, v107
    v_mul_f32 v104, v104, v12
    v_mul_f32 v105, v105, v13
    v_cvt_pk_bf16_f32 v88, v104, v105
    v_fma_f32 v14, v14, v6, v6
    v_fma_f32 v15, v15, v6, v6
    v_rcp_f32 v14, v14
    v_rcp_f32 v15, v15
    v_mul_f32 v12, v92, v5
    v_mul_f32 v13, v93, v5
    v_exp_f32 v12, v12
    v_mul_f32 v108, v92, v108
    v_exp_f32 v13, v13
    v_mul_f32 v109, v93, v109
    v_mul_f32 v106, v106, v14
    v_mul_f32 v107, v107, v15
    v_cvt_pk_bf16_f32 v89, v106, v107
    v_fma_f32 v12, v12, v6, v6
    v_fma_f32 v13, v13, v6, v6
    v_rcp_f32 v12, v12
    v_rcp_f32 v13, v13
    v_mul_f32 v14, v94, v5
    v_mul_f32 v15, v95, v5
    v_exp_f32 v14, v14
    v_mul_f32 v110, v94, v110
    v_exp_f32 v15, v15
    v_mul_f32 v111, v95, v111
    v_mul_f32 v108, v108, v12
    v_mul_f32 v109, v109, v13
    v_cvt_pk_bf16_f32 v90, v108, v109
    v_fma_f32 v14, v14, v6, v6
    v_fma_f32 v15, v15, v6, v6
    v_rcp_f32 v14, v14
    v_rcp_f32 v15, v15
    v_mul_f32 v12, v96, v5
    v_mul_f32 v13, v97, v5
    v_exp_f32 v12, v12
    v_mul_f32 v112, v96, v112
    v_exp_f32 v13, v13
    v_mul_f32 v113, v97, v113
    v_mul_f32 v110, v110, v14
    v_mul_f32 v111, v111, v15
    v_cvt_pk_bf16_f32 v91, v110, v111
    buffer_store_dwordx4 v[88:91], v0, s[16:19], s49 offen offset:0 sc1
    v_fma_f32 v12, v12, v6, v6
    v_fma_f32 v13, v13, v6, v6
    v_rcp_f32 v12, v12
    v_rcp_f32 v13, v13
    v_mul_f32 v14, v98, v5
    v_mul_f32 v15, v99, v5
    v_exp_f32 v14, v14
    v_mul_f32 v114, v98, v114
    v_exp_f32 v15, v15
    v_mul_f32 v115, v99, v115
    v_mul_f32 v112, v112, v12
    v_mul_f32 v113, v113, v13
    v_cvt_pk_bf16_f32 v92, v112, v113
    v_fma_f32 v14, v14, v6, v6
    v_fma_f32 v15, v15, v6, v6
    v_rcp_f32 v14, v14
    v_rcp_f32 v15, v15
    v_mul_f32 v12, v100, v5
    v_mul_f32 v13, v101, v5
    v_exp_f32 v12, v12
    v_mul_f32 v116, v100, v116
    v_exp_f32 v13, v13
    v_mul_f32 v117, v101, v117
    v_mul_f32 v114, v114, v14
    v_mul_f32 v115, v115, v15
    v_cvt_pk_bf16_f32 v93, v114, v115
    v_fma_f32 v12, v12, v6, v6
    v_fma_f32 v13, v13, v6, v6
    v_rcp_f32 v12, v12
    v_rcp_f32 v13, v13
    v_mul_f32 v14, v102, v5
    v_mul_f32 v15, v103, v5
    v_exp_f32 v14, v14
    v_mul_f32 v118, v102, v118
    v_exp_f32 v15, v15
    v_mul_f32 v119, v103, v119
    v_mul_f32 v116, v116, v12
    v_mul_f32 v117, v117, v13
    v_cvt_pk_bf16_f32 v94, v116, v117
    v_fma_f32 v14, v14, v6, v6
    v_fma_f32 v15, v15, v6, v6
    v_rcp_f32 v14, v14
    v_rcp_f32 v15, v15
    v_mul_f32 v118, v118, v14
    v_mul_f32 v119, v119, v15
    v_cvt_pk_bf16_f32 v95, v118, v119
    buffer_store_dwordx4 v[92:95], v0, s[16:19], s49 offen offset:1024 sc1
    s_bfe_u32 s36, s37, 0x3000c
    s_lshl_b32 s36, s36, 10
    s_add_u32 s36, s36, s56
    buffer_load_dwordx4 v[224:227], v0, s[16:19], s36 offen sc1
    buffer_load_dwordx4 v[228:231], v3, s[16:19], s36 offen sc1
    s_bfe_u32 s36, s37, 0x30010
    s_lshl_b32 s36, s36, 10
    s_add_u32 s36, s36, s56
    buffer_load_dwordx4 v[232:235], v0, s[16:19], s36 offen sc1
    buffer_load_dwordx4 v[236:239], v3, s[16:19], s36 offen sc1
    s_bfe_u32 s36, s37, 0x30014
    s_lshl_b32 s36, s36, 10
    s_add_u32 s36, s36, s56
    buffer_load_dwordx4 v[240:243], v0, s[16:19], s36 offen sc1
    buffer_load_dwordx4 v[244:247], v3, s[16:19], s36 offen sc1
    s_bfe_u32 s36, s37, 0x30018
    s_lshl_b32 s36, s36, 10
    s_add_u32 s36, s36, s56
    buffer_load_dwordx4 v[248:251], v0, s[16:19], s36 offen sc1
    buffer_load_dwordx4 v[252:255], v3, s[16:19], s36 offen sc1
    v_add_u32 v2, s41, v0
    v_add_u32 v21, 0x10000, v2
    v_add_u32 v5, 0x20000, v2
    s_add_u32 s50, s50, 65536
    s_add_u32 s57, s57, 65536
    s_add_u32 s56, s56, 114688
    s_waitcnt vmcnt(14)
    v_mfma_f32_32x32x16_bf16 v[24:39], v[200:203], v[144:147], 0
    v_mfma_f32_32x32x16_bf16 v[56:71], v[204:207], v[144:147], 0
    v_mfma_f32_32x32x16_bf16 v[40:55], v[200:203], v[148:151], 0
    v_mfma_f32_32x32x16_bf16 v[72:87], v[204:207], v[148:151], 0
    s_waitcnt vmcnt(12)
    v_mfma_f32_32x32x16_bf16 v[24:39], v[208:211], v[152:155], v[24:39]
    ds_read_b128 v[144:147], v21 offset:16384
    v_mfma_f32_32x32x16_bf16 v[56:71], v[212:215], v[152:155], v[56:71]
    ds_read_b128 v[148:151], v21 offset:17408
    v_mfma_f32_32x32x16_bf16 v[40:55], v[208:211], v[156:159], v[40:55]
    v_mfma_f32_32x32x16_bf16 v[72:87], v[212:215], v[156:159], v[72:87]
    s_waitcnt vmcnt(10)
    v_mfma_f32_32x32x16_bf16 v[24:39], v[216:219], v[160:163], v[24:39]
    ds_read_b128 v[152:155], v21 offset:32768
    v_mfma_f32_32x32x16_bf16 v[56:71], v[220:223], v[160:163], v[56:71]
    ds_read_b128 v[156:159], v21 offset:33792
    v_mfma_f32_32x32x16_bf16 v[40:55], v[216:219], v[164:167], v[40:55]
    v_mfma_f32_32x32x16_bf16 v[72:87], v[220:223], v[164:167], v[72:87]
    s_waitcnt vmcnt(8)
    s_mov_b64 exec, 1
    buffer_atomic_swap v4, off, s[16:19], s50 offset:0 sc1
    s_mov_b64 exec, -1
    s_waitcnt vmcnt(7)
    v_mfma_f32_32x32x16_bf16 v[24:39], v[224:227], v[168:171], v[24:39]
    ds_read_b128 v[160:163], v5 offset:16384
    v_mfma_f32_32x32x16_bf16 v[56:71], v[228:231], v[168:171], v[56:71]
    ds_read_b128 v[164:167], v5 offset:17408
    v_mfma_f32_32x32x16_bf16 v[40:55], v[224:227], v[172:175], v[40:55]
    v_mfma_f32_32x32x16_bf16 v[72:87], v[228:231], v[172:175], v[72:87]
    s_waitcnt vmcnt(5)
    v_mfma_f32_32x32x16_bf16 v[24:39], v[232:235], v[176:179], v[24:39]
    ds_read_b128 v[168:171], v21 offset:0
    v_mfma_f32_32x32x16_bf16 v[56:71], v[236:239], v[176:179], v[56:71]
    ds_read_b128 v[172:175], v21 offset:1024
    v_mfma_f32_32x32x16_bf16 v[40:55], v[232:235], v[180:183], v[40:55]
    v_mfma_f32_32x32x16_bf16 v[72:87], v[236:239], v[180:183], v[72:87]
    s_waitcnt vmcnt(3)
    v_mfma_f32_32x32x16_bf16 v[24:39], v[240:243], v[184:187], v[24:39]
    ds_read_b128 v[176:179], v21 offset:49152
    v_mfma_f32_32x32x16_bf16 v[56:71], v[244:247], v[184:187], v[56:71]
    ds_read_b128 v[180:183], v21 offset:50176
    v_mfma_f32_32x32x16_bf16 v[40:55], v[240:243], v[188:191], v[40:55]
    v_mov_b32 v20, 0
    s_mov_b64 exec, 0xff
    buffer_atomic_or v20, v7, s[16:19], s57 offen sc0 sc1
    s_mov_b64 exec, -1
    v_mfma_f32_32x32x16_bf16 v[72:87], v[244:247], v[188:191], v[72:87]
    s_waitcnt vmcnt(2)
    v_mfma_f32_32x32x16_bf16 v[24:39], v[248:251], v[192:195], v[24:39]
    ds_read_b128 v[184:187], v5 offset:0
    v_mfma_f32_32x32x16_bf16 v[56:71], v[252:255], v[192:195], v[56:71]
    ds_read_b128 v[188:191], v5 offset:1024
    v_mfma_f32_32x32x16_bf16 v[40:55], v[248:251], v[196:199], v[40:55]
    v_mfma_f32_32x32x16_bf16 v[72:87], v[252:255], v[196:199], v[72:87]
    v_bfe_u32 v17, v0, 9, 1
    v_bfe_u32 v18, v0, 4, 1
    v_lshl_add_u32 v16, v17, 1, v18
    ds_read_b128 v[192:195], v2 offset:0
    ds_read_b128 v[196:199], v2 offset:1024
    v_bfe_u32 v18, v0, 8, 1
    v_lshl_add_u32 v16, v16, 5, v18
    v_mul_u32_u24 v16, 896, v16
    v_bfe_u32 v18, v0, 5, 3
    v_lshl_add_u32 v16, v18, 3, v16
    s_lshr_b32 s44, s29, 1
    s_lshr_b32 s45, s43, 3
    s_lshl2_add_u32 s44, s44, s45
    s_and_b32 s45, s29, 1
    s_lshl1_add_u32 s44, s44, s45
    s_lshl_b32 s44, s44, 5
    s_and_b32 s45, s43, 7
    s_add_u32 s44, s44, s45
    s_lshl3_add_u32 s44, s44, s30
    s_mul_i32 s44, s44, 448
    s_lshl_b32 s45, s3, 6
    s_add_u32 s34, s44, s45
    s_mov_b64 exec, 0xff
    s_waitcnt vmcnt(0)
    s_movk_i32 s58, 0x4000
L_pt_8:
    v_cmp_ne_u32 vcc, v4, v20
    s_sub_u32 s58, s58, 1
    s_cbranch_vccz L_po_9
    s_cbranch_scc1 L_po_9
    s_sleep 2
    v_mov_b32 v20, 0
    buffer_atomic_or v20, v7, s[16:19], s57 offen sc0 sc1
    s_waitcnt vmcnt(0)
    s_branch L_pt_8
L_po_9:
    s_mov_b64 exec, -1
    s_and_b32 s44, s29, 1
    s_andn2_b32 s0, s57, 0x3ff
    s_lshl_b32 s44, s44, 6
    s_add_u32 s0, s0, s44
    s_add_u32 s0, s0, 128
    s_bfe_u32 s36, s37, 0x30000
    s_lshl_b32 s36, s36, 10
    s_add_u32 s36, s36, s56
    buffer_load_dwordx4 v[88:91], v0, s[16:19], s36 offen sc1
    buffer_load_dwordx4 v[116:119], v3, s[16:19], s36 offen sc1
    v_mov_b32 v20, 0
    s_mov_b64 exec, 0x7fff
    buffer_atomic_or v20, v7, s[16:19], s0 offen sc0 sc1
    s_mov_b64 exec, -1
    s_bfe_u32 s36, s37, 0x30004
    s_lshl_b32 s36, s36, 10
    s_add_u32 s36, s36, s56
    buffer_load_dwordx4 v[92:95], v0, s[16:19], s36 offen sc1
    s_bfe_u32 s36, s37, 0x30008
    s_lshl_b32 s36, s36, 10
    s_add_u32 s36, s36, s56
    buffer_load_dwordx4 v[96:99], v0, s[16:19], s36 offen sc1
    s_bfe_u32 s36, s37, 0x3000c
    s_lshl_b32 s36, s36, 10
    s_add_u32 s36, s36, s56
    buffer_load_dwordx4 v[100:103], v0, s[16:19], s36 offen sc1
    s_bfe_u32 s36, s37, 0x30010
    s_lshl_b32 s36, s36, 10
    s_add_u32 s36, s36, s56
    buffer_load_dwordx4 v[104:107], v0, s[16:19], s36 offen sc1
    s_bfe_u32 s36, s37, 0x30014
    s_lshl_b32 s36, s36, 10
    s_add_u32 s36, s36, s56
    buffer_load_dwordx4 v[108:111], v0, s[16:19], s36 offen sc1
    s_bfe_u32 s36, s37, 0x30018
    s_lshl_b32 s36, s36, 10
    s_add_u32 s36, s36, s56
    buffer_load_dwordx4 v[112:115], v0, s[16:19], s36 offen sc1
    s_bfe_u32 s36, s37, 0x30004
    s_lshl_b32 s36, s36, 10
    s_add_u32 s36, s36, s56
    buffer_load_dwordx4 v[120:123], v3, s[16:19], s36 offen sc1
    s_bfe_u32 s36, s37, 0x30008
    s_lshl_b32 s36, s36, 10
    s_add_u32 s36, s36, s56
    buffer_load_dwordx4 v[124:127], v3, s[16:19], s36 offen sc1
    s_bfe_u32 s36, s37, 0x3000c
    s_lshl_b32 s36, s36, 10
    s_add_u32 s36, s36, s56
    buffer_load_dwordx4 v[128:131], v3, s[16:19], s36 offen sc1
    s_bfe_u32 s36, s37, 0x30010
    s_lshl_b32 s36, s36, 10
    s_add_u32 s36, s36, s56
    buffer_load_dwordx4 v[132:135], v3, s[16:19], s36 offen sc1
    s_bfe_u32 s36, s37, 0x30014
    s_lshl_b32 s36, s36, 10
    s_add_u32 s36, s36, s56
    buffer_load_dwordx4 v[136:139], v3, s[16:19], s36 offen sc1
    s_bfe_u32 s36, s37, 0x30018
    s_lshl_b32 s36, s36, 10
    s_add_u32 s36, s36, s56
    buffer_load_dwordx4 v[140:143], v3, s[16:19], s36 offen sc1
    buffer_load_dwordx2 v[12:13], v16, s[4:7], s34 offen offset:0
    buffer_load_dwordx2 v[14:15], v16, s[4:7], s34 offen offset:1792
    v_bfe_u32 v248, v1, 7, 2
    v_bfe_u32 v246, v1, 4, 3
    s_lshl_b32 s45, s3, 5
    v_lshl_add_u32 v248, v246, 2, v248
    s_and_b32 s44, s29, 1
    v_add_u32 v248, s45, v248
    s_mul_i32 s44, s44, 112
    v_cvt_f32_u32 v248, v248
    s_lshr_b32 s45, s29, 1
    s_add_u32 s44, s44, s45
    v_mul_f32 v248, 0x3b124925, v248
    v_mad_u32_u24 v246, v17, 56, s44
    v_cvt_f32_u32 v246, v246
    v_mul_f32 v240, v246, v248
    v_add_f32 v248, v248, v248
    v_add_f32 v242, v240, v248
    v_cos_f32 v246, v248
    v_sin_f32 v241, -v240
    v_cos_f32 v240, v240
    v_sin_f32 v243, -v242
    v_cos_f32 v242, v242
    v_add_f32 v246, v246, v246
    v_mov_b32 v247, v246
    v_pk_fma_f32 v[244:245], v[246:247], v[242:243], v[240:241] neg_lo:[0,0,1] neg_hi:[0,0,1]
    v_cvt_pk_bf16_f32 v200, v240, v241
    v_pk_fma_f32 v[240:241], v[246:247], v[244:245], v[242:243] neg_lo:[0,0,1] neg_hi:[0,0,1]
    v_cvt_pk_bf16_f32 v201, v242, v243
    v_pk_fma_f32 v[242:243], v[246:247], v[240:241], v[244:245] neg_lo:[0,0,1] neg_hi:[0,0,1]
    v_cvt_pk_bf16_f32 v202, v244, v245
    v_pk_fma_f32 v[244:245], v[246:247], v[242:243], v[240:241] neg_lo:[0,0,1] neg_hi:[0,0,1]
    v_cvt_pk_bf16_f32 v203, v240, v241
    v_pk_fma_f32 v[240:241], v[246:247], v[244:245], v[242:243] neg_lo:[0,0,1] neg_hi:[0,0,1]
    v_cvt_pk_bf16_f32 v204, v242, v243
    v_pk_fma_f32 v[242:243], v[246:247], v[240:241], v[244:245] neg_lo:[0,0,1] neg_hi:[0,0,1]
    v_cvt_pk_bf16_f32 v205, v244, v245
    v_pk_fma_f32 v[244:245], v[246:247], v[242:243], v[240:241] neg_lo:[0,0,1] neg_hi:[0,0,1]
    v_cvt_pk_bf16_f32 v206, v240, v241
    v_pk_fma_f32 v[240:241], v[246:247], v[244:245], v[242:243] neg_lo:[0,0,1] neg_hi:[0,0,1]
    v_cvt_pk_bf16_f32 v207, v242, v243
    v_pk_fma_f32 v[242:243], v[246:247], v[240:241], v[244:245] neg_lo:[0,0,1] neg_hi:[0,0,1]
    v_cvt_pk_bf16_f32 v208, v244, v245
    v_pk_fma_f32 v[244:245], v[246:247], v[242:243], v[240:241] neg_lo:[0,0,1] neg_hi:[0,0,1]
    v_cvt_pk_bf16_f32 v209, v240, v241
    v_pk_fma_f32 v[240:241], v[246:247], v[244:245], v[242:243] neg_lo:[0,0,1] neg_hi:[0,0,1]
    v_cvt_pk_bf16_f32 v210, v242, v243
    v_pk_fma_f32 v[242:243], v[246:247], v[240:241], v[244:245] neg_lo:[0,0,1] neg_hi:[0,0,1]
    v_cvt_pk_bf16_f32 v211, v244, v245
    v_pk_fma_f32 v[244:245], v[246:247], v[242:243], v[240:241] neg_lo:[0,0,1] neg_hi:[0,0,1]
    v_cvt_pk_bf16_f32 v212, v240, v241
    v_pk_fma_f32 v[240:241], v[246:247], v[244:245], v[242:243] neg_lo:[0,0,1] neg_hi:[0,0,1]
    v_cvt_pk_bf16_f32 v213, v242, v243
    v_pk_fma_f32 v[242:243], v[246:247], v[240:241], v[244:245] neg_lo:[0,0,1] neg_hi:[0,0,1]
    v_cvt_pk_bf16_f32 v214, v244, v245
    v_pk_fma_f32 v[244:245], v[246:247], v[242:243], v[240:241] neg_lo:[0,0,1] neg_hi:[0,0,1]
    v_cvt_pk_bf16_f32 v215, v240, v241
    v_pk_fma_f32 v[240:241], v[246:247], v[244:245], v[242:243] neg_lo:[0,0,1] neg_hi:[0,0,1]
    v_cvt_pk_bf16_f32 v216, v242, v243
    v_pk_fma_f32 v[242:243], v[246:247], v[240:241], v[244:245] neg_lo:[0,0,1] neg_hi:[0,0,1]
    v_cvt_pk_bf16_f32 v217, v244, v245
    v_pk_fma_f32 v[244:245], v[246:247], v[242:243], v[240:241] neg_lo:[0,0,1] neg_hi:[0,0,1]
    v_cvt_pk_bf16_f32 v218, v240, v241
    v_pk_fma_f32 v[240:241], v[246:247], v[244:245], v[242:243] neg_lo:[0,0,1] neg_hi:[0,0,1]
    v_cvt_pk_bf16_f32 v219, v242, v243
    v_pk_fma_f32 v[242:243], v[246:247], v[240:241], v[244:245] neg_lo:[0,0,1] neg_hi:[0,0,1]
    v_cvt_pk_bf16_f32 v220, v244, v245
    v_pk_fma_f32 v[244:245], v[246:247], v[242:243], v[240:241] neg_lo:[0,0,1] neg_hi:[0,0,1]
    v_cvt_pk_bf16_f32 v221, v240, v241
    v_pk_fma_f32 v[240:241], v[246:247], v[244:245], v[242:243] neg_lo:[0,0,1] neg_hi:[0,0,1]
    v_cvt_pk_bf16_f32 v222, v242, v243
    v_pk_fma_f32 v[242:243], v[246:247], v[240:241], v[244:245] neg_lo:[0,0,1] neg_hi:[0,0,1]
    v_cvt_pk_bf16_f32 v223, v244, v245
    v_pk_fma_f32 v[244:245], v[246:247], v[242:243], v[240:241] neg_lo:[0,0,1] neg_hi:[0,0,1]
    v_cvt_pk_bf16_f32 v224, v240, v241
    v_pk_fma_f32 v[240:241], v[246:247], v[244:245], v[242:243] neg_lo:[0,0,1] neg_hi:[0,0,1]
    v_cvt_pk_bf16_f32 v225, v242, v243
    v_cvt_pk_bf16_f32 v226, v244, v245
    v_cvt_pk_bf16_f32 v227, v240, v241
    s_cmp_eq_u32 s29, 0
    s_cselect_b32 exec_lo, -1, 0
    s_mov_b32 exec_hi, 0
    v_lshlrev_b32 v200, 24, v0
    v_and_b32 v200, 0x80000000, v200
    v_or_b32 v200, 0x3f003f00, v200
    s_mov_b64 exec, -1
    s_mov_b64 exec, 0x7fff
    s_waitcnt vmcnt(14)
    s_movk_i32 s58, 0x4000
L_pt_10:
    v_cmp_ne_u32 vcc, v4, v20
    s_sub_u32 s58, s58, 1
    s_cbranch_vccz L_po_11
    s_cbranch_scc1 L_po_11
    s_sleep 2
    v_mov_b32 v20, 0
    buffer_atomic_or v20, v7, s[16:19], s0 offen sc0 sc1
    s_waitcnt vmcnt(0)
    s_branch L_pt_10
L_po_11:
    s_mov_b64 exec, -1
    s_lshl1_add_u32 s44, s43, s30
    s_lshl2_add_u32 s44, s44, s29
    s_mul_i32 s44, s44, 7168
    s_add_u32 s44, s44, 5242880
    s_waitcnt lgkmcnt(0)
    s_add_u32 m0, s41, 0
    s_nop 0
    buffer_load_dwordx4 v0, s[16:19], s44 offen offset:0 sc1 lds
    buffer_load_dwordx4 v0, s[16:19], s44 offen offset:1024 sc1 lds
    s_add_u32 m0, s41, 16384
    s_add_u32 s44, s44, 2048
    buffer_load_dwordx4 v0, s[16:19], s44 offen offset:0 sc1 lds
    buffer_load_dwordx4 v0, s[16:19], s44 offen offset:1024 sc1 lds
    s_add_u32 m0, s41, 131072
    s_add_u32 s44, s44, 2048
    buffer_load_dwordx4 v0, s[16:19], s44 offen offset:0 sc1 lds
    buffer_load_dwordx4 v0, s[16:19], s44 offen offset:1024 sc1 lds
    s_add_u32 m0, s41, 147456
    s_add_u32 s44, s44, 2048
    buffer_load_dwordx4 v0, s[16:19], s44 offen offset:0 sc1 lds
    v_and_b32 v21, 0x2f0, v0
    v_bfe_u32 v2, v0, 8, 1
    v_lshl_add_u32 v21, v2, 3, v21
    v_add_u32 v21, s41, v21
    v_add_u32 v2, 0x20000, v21
    s_add_u32 m0, s41, 0xc780
    v_mfma_f32_32x32x16_bf16 v[24:39], v[88:91], v[144:147], v[24:39]
    v_mfma_f32_32x32x16_bf16 v[40:55], v[88:91], v[148:151], v[40:55]
    s_waitcnt vmcnt(20)
    v_mfma_f32_32x32x16_bf16 v[24:39], v[92:95], v[152:155], v[24:39]
    v_mfma_f32_32x32x16_bf16 v[40:55], v[92:95], v[156:159], v[40:55]
    s_waitcnt vmcnt(19)
    v_mfma_f32_32x32x16_bf16 v[24:39], v[96:99], v[160:163], v[24:39]
    v_mfma_f32_32x32x16_bf16 v[40:55], v[96:99], v[164:167], v[40:55]
    s_waitcnt vmcnt(18)
    v_mfma_f32_32x32x16_bf16 v[24:39], v[100:103], v[168:171], v[24:39]
    v_mfma_f32_32x32x16_bf16 v[40:55], v[100:103], v[172:175], v[40:55]
    s_waitcnt vmcnt(17)
    v_mfma_f32_32x32x16_bf16 v[24:39], v[104:107], v[176:179], v[24:39]
    v_mfma_f32_32x32x16_bf16 v[40:55], v[104:107], v[180:183], v[40:55]
    s_waitcnt vmcnt(16)
    v_mfma_f32_32x32x16_bf16 v[24:39], v[108:111], v[184:187], v[24:39]
    v_mfma_f32_32x32x16_bf16 v[40:55], v[108:111], v[188:191], v[40:55]
    s_waitcnt vmcnt(15)
    v_mfma_f32_32x32x16_bf16 v[24:39], v[112:115], v[192:195], v[24:39]
    v_mfma_f32_32x32x16_bf16 v[40:55], v[112:115], v[196:199], v[40:55]
    v_mfma_f32_32x32x16_bf16 v[56:71], v[116:119], v[144:147], v[56:71]
    v_mfma_f32_32x32x16_bf16 v[72:87], v[116:119], v[148:151], v[72:87]
    s_nop 8
    v_cvt_pk_bf16_f32 v24, v24, v25
    ds_write_addtid_b32 v24 offset:14464
    v_cvt_pk_bf16_f32 v25, v26, v27
    ds_write_addtid_b32 v25 offset:14720
    v_cvt_pk_bf16_f32 v26, v28, v29
    s_waitcnt vmcnt(14)
    v_mfma_f32_32x32x16_bf16 v[56:71], v[120:123], v[152:155], v[56:71]
    ds_write_addtid_b32 v26 offset:14976
    v_cvt_pk_bf16_f32 v27, v30, v31
    ds_write_addtid_b32 v27 offset:15232
    v_cvt_pk_bf16_f32 v28, v32, v33
    ds_write_addtid_b32 v28 offset:15488
    v_mfma_f32_32x32x16_bf16 v[72:87], v[120:123], v[156:159], v[72:87]
    v_cvt_pk_bf16_f32 v29, v34, v35
    ds_write_addtid_b32 v29 offset:15744
    v_cvt_pk_bf16_f32 v30, v36, v37
    ds_write_addtid_b32 v30 offset:16000
    v_cvt_pk_bf16_f32 v31, v38, v39
    s_waitcnt vmcnt(13)
    v_mfma_f32_32x32x16_bf16 v[56:71], v[124:127], v[160:163], v[56:71]
    ds_write_addtid_b32 v31 offset:16256
    v_cvt_pk_bf16_f32 v40, v40, v41
    ds_write_addtid_b32 v40 offset:30848
    v_cvt_pk_bf16_f32 v41, v42, v43
    ds_write_addtid_b32 v41 offset:31104
    v_mfma_f32_32x32x16_bf16 v[72:87], v[124:127], v[164:167], v[72:87]
    v_cvt_pk_bf16_f32 v42, v44, v45
    ds_write_addtid_b32 v42 offset:31360
    v_cvt_pk_bf16_f32 v43, v46, v47
    ds_write_addtid_b32 v43 offset:31616
    v_cvt_pk_bf16_f32 v44, v48, v49
    s_waitcnt vmcnt(12)
    v_mfma_f32_32x32x16_bf16 v[56:71], v[128:131], v[168:171], v[56:71]
    ds_write_addtid_b32 v44 offset:31872
    v_cvt_pk_bf16_f32 v45, v50, v51
    ds_write_addtid_b32 v45 offset:32128
    v_cvt_pk_bf16_f32 v46, v52, v53
    ds_write_addtid_b32 v46 offset:32384
    v_mfma_f32_32x32x16_bf16 v[72:87], v[128:131], v[172:175], v[72:87]
    v_cvt_pk_bf16_f32 v47, v54, v55
    ds_write_addtid_b32 v47 offset:32640
    s_waitcnt vmcnt(11)
    v_mfma_f32_32x32x16_bf16 v[56:71], v[132:135], v[176:179], v[56:71]
    v_mfma_f32_32x32x16_bf16 v[72:87], v[132:135], v[180:183], v[72:87]
    s_waitcnt vmcnt(10)
    v_mfma_f32_32x32x16_bf16 v[56:71], v[136:139], v[184:187], v[56:71]
    v_mfma_f32_32x32x16_bf16 v[72:87], v[136:139], v[188:191], v[72:87]
    s_waitcnt vmcnt(9)
    v_mfma_f32_32x32x16_bf16 v[56:71], v[140:143], v[192:195], v[56:71]
    v_mfma_f32_32x32x16_bf16 v[72:87], v[140:143], v[196:199], v[72:87]
    s_waitcnt vmcnt(6)
    ds_read_b64_tr_b16 v[228:229], v21 offset:0
    ds_read_b64_tr_b16 v[230:231], v21 offset:256
    s_waitcnt vmcnt(5)
    ds_read_b64_tr_b16 v[232:233], v21 offset:1024
    ds_read_b64_tr_b16 v[234:235], v21 offset:1280
    s_waitcnt lgkmcnt(2)
    v_mfma_f32_32x32x16_bf16 v[240:255], v[228:231], v[200:203], 0
    s_waitcnt vmcnt(4)
    ds_read_b64_tr_b16 v[236:237], v21 offset:16384
    ds_read_b64_tr_b16 v[238:239], v21 offset:16640
    v_cvt_pk_bf16_f32 v56, v56, v57
    ds_write_addtid_b32 v56 offset:47232
    s_waitcnt lgkmcnt(3)
    v_mfma_f32_32x32x16_bf16 v[240:255], v[232:235], v[204:207], v[240:255]
    s_waitcnt vmcnt(3)
    ds_read_b64_tr_b16 v[228:229], v21 offset:17408
    ds_read_b64_tr_b16 v[230:231], v21 offset:17664
    v_cvt_pk_bf16_f32 v57, v58, v59
    ds_write_addtid_b32 v57 offset:47488
    v_cvt_pk_bf16_f32 v58, v60, v61
    ds_write_addtid_b32 v58 offset:47744
    v_cvt_pk_bf16_f32 v59, v62, v63
    ds_write_addtid_b32 v59 offset:48000
    v_cvt_pk_bf16_f32 v60, v64, v65
    ds_write_addtid_b32 v60 offset:48256
    s_waitcnt lgkmcnt(7)
    v_mfma_f32_32x32x16_bf16 v[240:255], v[236:239], v[208:211], v[240:255]
    s_waitcnt vmcnt(2)
    ds_read_b64_tr_b16 v[232:233], v2 offset:0
    ds_read_b64_tr_b16 v[234:235], v2 offset:256
    v_cvt_pk_bf16_f32 v61, v66, v67
    ds_write_addtid_b32 v61 offset:48512
    v_cvt_pk_bf16_f32 v62, v68, v69
    ds_write_addtid_b32 v62 offset:48768
    v_cvt_pk_bf16_f32 v63, v70, v71
    ds_write_addtid_b32 v63 offset:49024
    v_cvt_pk_bf16_f32 v72, v72, v73
    ds_write_addtid_b32 v72 offset:63616
    s_waitcnt lgkmcnt(10)
    v_mfma_f32_32x32x16_bf16 v[240:255], v[228:231], v[212:215], v[240:255]
    s_waitcnt vmcnt(1)
    ds_read_b64_tr_b16 v[236:237], v2 offset:1024
    ds_read_b64_tr_b16 v[238:239], v2 offset:1280
    v_cvt_pk_bf16_f32 v73, v74, v75
    ds_write_addtid_b32 v73 offset:63872
    v_cvt_pk_bf16_f32 v74, v76, v77
    ds_write_addtid_b32 v74 offset:64128
    v_cvt_pk_bf16_f32 v75, v78, v79
    ds_write_addtid_b32 v75 offset:64384
    v_cvt_pk_bf16_f32 v76, v80, v81
    ds_write_addtid_b32 v76 offset:64640
    s_waitcnt lgkmcnt(10)
    v_mfma_f32_32x32x16_bf16 v[240:255], v[232:235], v[216:219], v[240:255]
    s_waitcnt vmcnt(0)
    ds_read_b64_tr_b16 v[228:229], v2 offset:16384
    ds_read_b64_tr_b16 v[230:231], v2 offset:16640
    v_cvt_pk_bf16_f32 v77, v82, v83
    ds_write_addtid_b32 v77 offset:64896
    v_cvt_pk_bf16_f32 v78, v84, v85
    ds_write_addtid_b32 v78 offset:65152
    v_cvt_pk_bf16_f32 v79, v86, v87
    ds_write_addtid_b32 v79 offset:65408
    s_waitcnt lgkmcnt(9)
    v_mfma_f32_32x32x16_bf16 v[240:255], v[236:239], v[220:223], v[240:255]
    s_waitcnt lgkmcnt(3)
    v_mfma_f32_32x32x16_bf16 v[240:255], v[228:231], v[224:227], v[240:255]
    v_bfe_u32 v88, v0, 6, 2
    v_mul_u32_u24 v88, 2080, v88
    v_and_b32 v92, 0x330, v0
    s_lshl_b32 s44, s29, 9
    v_lshrrev_b32 v92, 1, v92
    v_add3_u32 v92, v92, v88, s44
    s_mov_b32 m0, s41
    s_nop 4
    v_add_f32 v228, v240, v248
    v_sub_f32 v248, v240, v248
    v_add_f32 v229, v241, v249
    v_sub_f32 v249, v241, v249
    v_add_f32 v230, v242, v250
    v_sub_f32 v250, v242, v250
    v_add_f32 v231, v243, v251
    v_sub_f32 v251, v243, v251
    v_add_f32 v232, v244, v252
    v_sub_f32 v252, v244, v252
    v_add_f32 v233, v245, v253
    v_sub_f32 v253, v245, v253
    v_add_f32 v234, v246, v254
    v_sub_f32 v254, v246, v254
    v_add_f32 v235, v247, v255
    v_sub_f32 v255, v247, v255
    v_cvt_pk_bf16_f32 v228, v228, v229
    ds_write_addtid_b32 v228 offset:0
    v_cvt_pk_bf16_f32 v230, v230, v231
    ds_write_addtid_b32 v230 offset:256
    v_cvt_pk_bf16_f32 v232, v232, v233
    ds_write_addtid_b32 v232 offset:512
    v_cvt_pk_bf16_f32 v234, v234, v235
    ds_write_addtid_b32 v234 offset:768
    v_cvt_pk_bf16_f32 v248, v248, v249
    ds_write_addtid_b32 v248 offset:1024
    v_cvt_pk_bf16_f32 v250, v250, v251
    ds_write_addtid_b32 v250 offset:1280
    v_cvt_pk_bf16_f32 v252, v252, v253
    ds_write_addtid_b32 v252 offset:1536
    v_cvt_pk_bf16_f32 v254, v254, v255
    ds_write_addtid_b32 v254 offset:1792
    v_xor_b32 v93, 32, v92
    v_xor_b32 v94, 64, v92
    v_xor_b32 v95, 96, v92
    s_lshl_b32 s44, s30, 14
    s_add_u32 s44, s44, 65536
    v_add_u32 v88, s44, v92
    v_add_u32 v89, s44, v93
    v_add_u32 v90, s44, v94
    v_add_u32 v91, s44, v95
    v_mov_b32 v24, 0
    v_mov_b32 v25, 0
    v_mov_b32 v26, 0
    v_mov_b32 v27, 0
    v_mov_b32 v28, 0
    v_mov_b32 v29, 0
    v_mov_b32 v30, 0
    v_mov_b32 v31, 0
    v_mov_b32 v32, 0
    v_mov_b32 v33, 0
    v_mov_b32 v34, 0
    v_mov_b32 v35, 0
    v_mov_b32 v36, 0
    v_mov_b32 v37, 0
    v_mov_b32 v38, 0
    v_mov_b32 v39, 0
    s_cmp_eq_u32 s30, 0
    s_cselect_b32 s45, s48, 0xbf80bf80
    s_mov_b32 s46, 0x48e00000
    s_waitcnt lgkmcnt(0)
    s_barrier
    ds_read_b64_tr_b16 v[96:97], v88 offset:0
    ds_read_b64_tr_b16 v[98:99], v88 offset:8192
    ds_read_b64_tr_b16 v[100:101], v92 offset:0
    ds_read_b64_tr_b16 v[102:103], v89 offset:0
    ds_read_b64_tr_b16 v[104:105], v89 offset:8192
    ds_read_b64_tr_b16 v[106:107], v93 offset:0
    ds_read_b64_tr_b16 v[108:109], v90 offset:0
    ds_read_b64_tr_b16 v[110:111], v90 offset:8192
    ds_read_b64_tr_b16 v[112:113], v94 offset:0
    ds_read_b64_tr_b16 v[114:115], v91 offset:0
    ds_read_b64_tr_b16 v[116:117], v91 offset:8192
    ds_read_b64_tr_b16 v[118:119], v95 offset:0
    ds_read_b64_tr_b16 v[120:121], v88 offset:32768
    ds_read_b64_tr_b16 v[122:123], v88 offset:40960
    ds_read_b64_tr_b16 v[124:125], v92 offset:8192
    ds_read_b64_tr_b16 v[126:127], v89 offset:32768
    ds_read_b64_tr_b16 v[128:129], v89 offset:40960
    ds_read_b64_tr_b16 v[130:131], v93 offset:8192
    ds_read_b64_tr_b16 v[132:133], v90 offset:32768
    ds_read_b64_tr_b16 v[134:135], v90 offset:40960
    ds_read_b64_tr_b16 v[136:137], v94 offset:8192
    ds_read_b64_tr_b16 v[138:139], v91 offset:32768
    ds_read_b64_tr_b16 v[140:141], v91 offset:40960
    ds_read_b64_tr_b16 v[142:143], v95 offset:8192
    v_lshlrev_b32 v48, 16, v12
    v_and_b32 v49, 0xffff0000, v12
    v_lshlrev_b32 v50, 16, v13
    v_and_b32 v51, 0xffff0000, v13
    v_lshlrev_b32 v52, 16, v14
    v_and_b32 v53, 0xffff0000, v14
    v_lshlrev_b32 v54, 16, v15
    v_and_b32 v55, 0xffff0000, v15
    s_waitcnt lgkmcnt(15)
    v_dot2c_f32_bf16 v24, s48, v96
    v_dot2c_f32_bf16 v24, s48, v97
    v_dot2c_f32_bf16 v24, s48, v98
    v_dot2c_f32_bf16 v24, s48, v99
    v_dot2c_f32_bf16 v25, s48, v102
    v_dot2c_f32_bf16 v25, s48, v103
    v_dot2c_f32_bf16 v25, s48, v104
    v_dot2c_f32_bf16 v25, s48, v105
    v_dot2c_f32_bf16 v26, s48, v108
    v_dot2c_f32_bf16 v26, s48, v109
    v_dot2c_f32_bf16 v26, s48, v110
    v_dot2c_f32_bf16 v26, s48, v111
    s_waitcnt lgkmcnt(12)
    v_dot2c_f32_bf16 v27, s48, v114
    v_dot2c_f32_bf16 v27, s48, v115
    v_dot2c_f32_bf16 v27, s48, v116
    v_dot2c_f32_bf16 v27, s48, v117
    v_dot2c_f32_bf16 v32, s48, v100
    v_dot2c_f32_bf16 v32, s45, v101
    v_dot2c_f32_bf16 v33, s48, v106
    v_dot2c_f32_bf16 v33, s45, v107
    v_dot2c_f32_bf16 v34, s48, v112
    v_dot2c_f32_bf16 v34, s45, v113
    v_dot2c_f32_bf16 v35, s48, v118
    v_dot2c_f32_bf16 v35, s45, v119
    v_mul_f32 v40, 0xbfb8aa3b, v24
    v_mul_f32 v41, 0xbfb8aa3b, v25
    v_mul_f32 v42, 0xbfb8aa3b, v26
    v_mul_f32 v43, 0xbfb8aa3b, v27
    v_exp_f32 v40, v40
    v_mul_f32 v32, v32, v24
    v_exp_f32 v41, v41
    v_mul_f32 v33, v33, v25
    v_exp_f32 v42, v42
    v_mul_f32 v34, v34, v26
    v_exp_f32 v43, v43
    v_mul_f32 v35, v35, v27
    v_fma_f32 v40, v40, s46, s46
    v_fma_f32 v41, v41, s46, s46
    v_fma_f32 v42, v42, s46, s46
    v_fma_f32 v43, v43, s46, s46
    v_rcp_f32 v40, v40
    v_rcp_f32 v41, v41
    v_rcp_f32 v42, v42
    v_rcp_f32 v43, v43
    v_fma_f32 v48, v32, v40, v48
    v_fma_f32 v49, v33, v41, v49
    v_fma_f32 v50, v34, v42, v50
    v_fma_f32 v51, v35, v43, v51
    v_cvt_pk_bf16_f32 v48, v48, v49
    v_cvt_pk_bf16_f32 v49, v50, v51
    buffer_store_dwordx2 v[48:49], v16, s[20:23], s34 offen offset:0
    s_waitcnt lgkmcnt(9)
    v_dot2c_f32_bf16 v28, s48, v120
    v_dot2c_f32_bf16 v28, s48, v121
    v_dot2c_f32_bf16 v28, s48, v122
    v_dot2c_f32_bf16 v28, s48, v123
    s_waitcnt lgkmcnt(6)
    v_dot2c_f32_bf16 v29, s48, v126
    v_dot2c_f32_bf16 v29, s48, v127
    v_dot2c_f32_bf16 v29, s48, v128
    v_dot2c_f32_bf16 v29, s48, v129
    s_waitcnt lgkmcnt(3)
    v_dot2c_f32_bf16 v30, s48, v132
    v_dot2c_f32_bf16 v30, s48, v133
    v_dot2c_f32_bf16 v30, s48, v134
    v_dot2c_f32_bf16 v30, s48, v135
    s_waitcnt lgkmcnt(0)
    v_dot2c_f32_bf16 v31, s48, v138
    v_dot2c_f32_bf16 v31, s48, v139
    v_dot2c_f32_bf16 v31, s48, v140
    v_dot2c_f32_bf16 v31, s48, v141
    v_dot2c_f32_bf16 v36, s48, v124
    v_dot2c_f32_bf16 v36, s45, v125
    v_dot2c_f32_bf16 v37, s48, v130
    v_dot2c_f32_bf16 v37, s45, v131
    v_dot2c_f32_bf16 v38, s48, v136
    v_dot2c_f32_bf16 v38, s45, v137
    v_dot2c_f32_bf16 v39, s48, v142
    v_dot2c_f32_bf16 v39, s45, v143
    v_mul_f32 v44, 0xbfb8aa3b, v28
    v_mul_f32 v45, 0xbfb8aa3b, v29
    v_mul_f32 v46, 0xbfb8aa3b, v30
    v_mul_f32 v47, 0xbfb8aa3b, v31
    v_exp_f32 v44, v44
    v_mul_f32 v36, v36, v28
    v_exp_f32 v45, v45
    v_mul_f32 v37, v37, v29
    v_exp_f32 v46, v46
    v_mul_f32 v38, v38, v30
    v_exp_f32 v47, v47
    v_mul_f32 v39, v39, v31
    v_fma_f32 v44, v44, s46, s46
    v_fma_f32 v45, v45, s46, s46
    v_fma_f32 v46, v46, s46, s46
    v_fma_f32 v47, v47, s46, s46
    v_rcp_f32 v44, v44
    v_rcp_f32 v45, v45
    v_rcp_f32 v46, v46
    v_rcp_f32 v47, v47
    v_fma_f32 v52, v36, v44, v52
    v_fma_f32 v53, v37, v45, v53
    v_fma_f32 v54, v38, v46, v54
    v_fma_f32 v55, v39, v47, v55
    v_cvt_pk_bf16_f32 v52, v52, v53
    v_cvt_pk_bf16_f32 v53, v54, v55
    buffer_store_dwordx2 v[52:53], v16, s[20:23], s34 offen offset:1792
    s_or_b32 s44, s2, s28
    s_cbranch_scc1 L_o_12
    s_mov_b64 exec, 1
    buffer_atomic_swap v4, off, s[16:19], s44 offset:0 sc1
    s_mov_b64 exec, -1
L_o_12:
    s_endpgm
L_spare:
    s_load_dwordx4 s[8:11], s[0:1], 8
    v_readfirstlane_b32 s28, v2
    v_and_b32 v2, 63, v0
    v_and_b32 v3, 31, v0
    v_lshrrev_b32 v6, 5, v2
    v_lshlrev_b32 v0, 4, v2
    s_sub_u32 s59, s2, 224
    v_lshlrev_b32 v8, 4, v3
    v_xor_b32 v9, 64, v8
    v_xor_b32 v10, 128, v8
    v_xor_b32 v11, 192, v8
    v_mul_u32_u24 v5, 450, v6
    v_add_u32 v8, v5, v8
    v_min_u32 v8, 896, v8
    v_add_u32 v9, v5, v9
    v_min_u32 v9, 896, v9
    v_add_u32 v10, v5, v10
    v_min_u32 v10, 896, v10
    v_add_u32 v11, v5, v11
    v_min_u32 v11, 896, v11
    s_lshr_b32 s44, s59, 2
    s_and_b32 s45, s59, 3
    s_lshl4_add_u32 s44, s44, s45
    s_lshl3_add_u32 s44, s44, s28
    s_mul_i32 s34, s44, 900
    s_lshl_b32 s36, s28, 13
    s_waitcnt lgkmcnt(0)
    s_mov_b64 s[12:13], s[10:11]
    s_mov_b32 s10, 921600
    s_mov_b32 s11, 0x00020000
    s_mov_b32 s14, 921600
    s_mov_b32 s15, 0x00020000
    s_add_u32 m0, s36, 0
    s_nop 0
    buffer_load_dwordx4 v8, s[8:11], s34 offen nt lds
    s_add_u32 m0, s36, 1024
    s_nop 0
    buffer_load_dwordx4 v8, s[12:15], s34 offen nt lds
    s_add_u32 m0, s36, 2048
    s_add_u32 s34, s34, 28800
    buffer_load_dwordx4 v9, s[8:11], s34 offen nt lds
    s_add_u32 m0, s36, 3072
    s_nop 0
    buffer_load_dwordx4 v9, s[12:15], s34 offen nt lds
    s_add_u32 m0, s36, 4096
    s_add_u32 s34, s34, 28800
    buffer_load_dwordx4 v10, s[8:11], s34 offen nt lds
    s_add_u32 m0, s36, 5120
    s_nop 0
    buffer_load_dwordx4 v10, s[12:15], s34 offen nt lds
    s_add_u32 m0, s36, 6144
    s_add_u32 s34, s34, 28800
    buffer_load_dwordx4 v11, s[8:11], s34 offen nt lds
    s_add_u32 m0, s36, 7168
    s_nop 0
    buffer_load_dwordx4 v11, s[12:15], s34 offen nt lds
    s_load_dword s33, s[16:17], 0
    s_mov_b32 s18, 16777216
    s_mov_b32 s19, 0x00020000
    s_cmp_lg_u32 s59, 31
    s_cbranch_scc1 L_o_13
    s_lshr_b32 s44, s28, 1
    s_lshl_b32 s44, s44, 9
    s_and_b32 s45, s28, 1
    s_add_u32 s44, s44, s45
    s_lshl_b32 s44, s44, 7
    s_add_u32 s44, s44, 524288
    v_lshlrev_b32 v12, 6, v0
    v_mov_b32 v13, 0
    buffer_atomic_or v13, v12, s[16:19], s44 offen sc1
L_o_13:
    v_cvt_f32_u32 v7, v3
    v_cvt_f32_u32 v5, v6
    s_lshr_b32 s44, s28, 2
    v_lshl_add_u32 v12, v3, 1, s44
    v_cvt_f32_u32 v12, v12
    v_mul_f32 v12, 0x3c800000, v12
    s_and_b32 s44, s28, 3
    s_lshl_b32 s44, s44, 3
    v_cvt_f32_u32 v13, s44
    v_mul_f32 v14, 0xbe800000, v5
    v_fma_f32 v24, v13, v12, v14
    v_fmamk_f32 v25, v12, 0x3f800000, v24
    v_fmamk_f32 v26, v12, 0x40000000, v24
    v_fmamk_f32 v27, v12, 0x40400000, v24
    v_fmamk_f32 v28, v12, 0x40800000, v24
    v_fmamk_f32 v29, v12, 0x40a00000, v24
    v_fmamk_f32 v30, v12, 0x40c00000, v24
    v_fmamk_f32 v31, v12, 0x40e00000, v24
    v_sin_f32 v32, -v24
    v_cos_f32 v24, v24
    v_sin_f32 v33, -v25
    v_cos_f32 v25, v25
    v_sin_f32 v34, -v26
    v_cos_f32 v26, v26
    v_sin_f32 v35, -v27
    v_cos_f32 v27, v27
    v_sin_f32 v36, -v28
    v_cos_f32 v28, v28
    v_sin_f32 v37, -v29
    v_cos_f32 v29, v29
    v_sin_f32 v38, -v30
    v_cos_f32 v30, v30
    v_sin_f32 v39, -v31
    v_cos_f32 v31, v31
    v_cvt_pk_bf16_f32 v40, v24, v25
    v_cvt_pk_bf16_f32 v41, v26, v27
    v_cvt_pk_bf16_f32 v42, v28, v29
    v_cvt_pk_bf16_f32 v43, v30, v31
    v_cvt_pk_bf16_f32 v44, v32, v33
    v_cvt_pk_bf16_f32 v45, v34, v35
    v_cvt_pk_bf16_f32 v46, v36, v37
    v_cvt_pk_bf16_f32 v47, v38, v39
    s_lshl_b32 s44, s28, 11
    s_add_u32 s44, s44, 65536
    v_add_u32 v15, s44, v0
    ds_write_b128 v15, v[40:43] offset:0
    ds_write_b128 v15, v[44:47] offset:1024
    s_lshr_b32 s44, s28, 1
    s_cmp_eq_u32 s44, 1
    s_cselect_b32 s45, 0x3a000000, 0
    s_cmp_eq_u32 s44, 2
    s_cselect_b32 s46, 0x3a000000, 0
    s_cmp_eq_u32 s44, 3
    s_cselect_b32 s46, 0x3c800000, s46
    v_mul_f32 v12, 0x3d000000, v7
    v_add_f32 v12, s45, v12
    v_mul_f32 v14, s46, v7
    s_and_b32 s44, s28, 1
    s_lshl_b32 s44, s44, 4
    v_lshl_add_u32 v13, v6, 2, s44
    v_cvt_f32_u32 v13, v13
    v_fma_f32 v24, v13, v12, v14
    v_fmamk_f32 v25, v12, 0x3f800000, v24
    v_fmamk_f32 v26, v12, 0x40000000, v24
    v_fmamk_f32 v27, v12, 0x40400000, v24
    v_fmamk_f32 v28, v12, 0x41000000, v24
    v_fmamk_f32 v29, v12, 0x41100000, v24
    v_fmamk_f32 v30, v12, 0x41200000, v24
    v_fmamk_f32 v31, v12, 0x41300000, v24
    v_sin_f32 v32, v24
    v_cos_f32 v24, v24
    v_sin_f32 v33, v25
    v_cos_f32 v25, v25
    v_sin_f32 v34, v26
    v_cos_f32 v26, v26
    v_sin_f32 v35, v27
    v_cos_f32 v27, v27
    v_sin_f32 v36, v28
    v_cos_f32 v28, v28
    v_sin_f32 v37, v29
    v_cos_f32 v29, v29
    v_sin_f32 v38, v30
    v_cos_f32 v30, v30
    v_sin_f32 v39, v31
    v_cos_f32 v31, v31
    v_cvt_pk_bf16_f32 v48, v24, v25
    v_cvt_pk_bf16_f32 v49, v26, v27
    v_cvt_pk_bf16_f32 v50, v28, v29
    v_cvt_pk_bf16_f32 v51, v30, v31
    v_cvt_pk_bf16_f32 v52, v32, v33
    v_cvt_pk_bf16_f32 v53, v34, v35
    v_cvt_pk_bf16_f32 v54, v36, v37
    v_cvt_pk_bf16_f32 v55, v38, v39
    v_xor_b32 v40, 0x80008000, v52
    v_xor_b32 v41, 0x80008000, v53
    v_xor_b32 v42, 0x80008000, v54
    v_xor_b32 v43, 0x80008000, v55
    s_mul_i32 s44, s28, 3072
    s_add_u32 s44, s44, 81920
    v_add_u32 v15, s44, v0
    ds_write_b128 v15, v[48:51] offset:0
    ds_write_b128 v15, v[52:55] offset:1024
    ds_write_b128 v15, v[40:43] offset:2048
    v_bfe_u32 v12, v2, 2, 2
    v_mul_u32_u24 v12, 2112, v12
    v_lshl_add_u32 v12, v6, 9, v12
    v_and_b32 v13, 16, v2
    v_lshl_add_u32 v12, v13, 1, v12
    v_and_b32 v13, 3, v2
    v_lshl_add_u32 v12, v13, 3, v12
    v_add_u32 v12, s36, v12
    v_xor_b32 v13, 64, v12
    v_xor_b32 v14, 128, v12
    v_xor_b32 v15, 192, v12
    v_lshrrev_b32 v16, 3, v3
    v_lshlrev_b32 v16, 16, v16
    v_lshl_add_u32 v16, v6, 7, v16
    v_and_b32 v17, 0x70, v0
    v_add_u32 v16, v16, v17
    s_lshl3_add_u32 s47, s59, s28
    s_lshl_b32 s44, s47, 8
    s_add_u32 s44, s44, 3145728
    s_waitcnt vmcnt(0)
    ds_read_b64_tr_b16 v[88:89], v12 offset:0
    ds_read_b64_tr_b16 v[90:91], v12 offset:1024
    ds_read_b64_tr_b16 v[92:93], v13 offset:0
    ds_read_b64_tr_b16 v[94:95], v13 offset:1024
    ds_read_b64_tr_b16 v[96:97], v14 offset:0
    ds_read_b64_tr_b16 v[98:99], v14 offset:1024
    ds_read_b64_tr_b16 v[100:101], v15 offset:0
    ds_read_b64_tr_b16 v[102:103], v15 offset:1024
    ds_read_b64_tr_b16 v[104:105], v12 offset:256
    ds_read_b64_tr_b16 v[106:107], v12 offset:1280
    ds_read_b64_tr_b16 v[108:109], v13 offset:256
    ds_read_b64_tr_b16 v[110:111], v13 offset:1280
    ds_read_b64_tr_b16 v[112:113], v14 offset:256
    ds_read_b64_tr_b16 v[114:115], v14 offset:1280
    ds_read_b64_tr_b16 v[116:117], v15 offset:256
    ds_read_b64_tr_b16 v[118:119], v15 offset:1280
    s_waitcnt lgkmcnt(14)
    buffer_store_dwordx4 v[88:91], v16, s[16:19], s44 offen sc1
    s_waitcnt lgkmcnt(12)
    s_add_u32 s44, s44, 262144
    buffer_store_dwordx4 v[92:95], v16, s[16:19], s44 offen sc1
    s_waitcnt lgkmcnt(10)
    s_add_u32 s44, s44, 262144
    buffer_store_dwordx4 v[96:99], v16, s[16:19], s44 offen sc1
    s_waitcnt lgkmcnt(8)
    s_add_u32 s44, s44, 262144
    buffer_store_dwordx4 v[100:103], v16, s[16:19], s44 offen sc1
    s_waitcnt lgkmcnt(6)
    s_add_u32 s44, s44, 262144
    buffer_store_dwordx4 v[104:107], v16, s[16:19], s44 offen sc1
    s_waitcnt lgkmcnt(4)
    s_add_u32 s44, s44, 262144
    buffer_store_dwordx4 v[108:111], v16, s[16:19], s44 offen sc1
    s_waitcnt lgkmcnt(2)
    s_add_u32 s44, s44, 262144
    buffer_store_dwordx4 v[112:115], v16, s[16:19], s44 offen sc1
    s_waitcnt lgkmcnt(0)
    s_add_u32 s44, s44, 262144
    s_mov_b32 exec_lo, 0xff
    s_mov_b32 exec_hi, 0xff
    buffer_store_dwordx4 v[116:119], v16, s[16:19], s44 offen sc1
    s_mov_b64 exec, -1
    s_mul_i32 s33, s33, 0x9E3779B1
    s_add_u32 s33, s33, 0x7F4A7C15
    v_mov_b32 v4, s33
    v_mul_f32 v12, 0x3a800000, v7
    v_mul_f32 v13, 4.0, v5
    v_mul_f32 v56, v12, v13
    v_fmamk_f32 v57, v12, 0x3f800000, v56
    v_fmamk_f32 v58, v12, 0x40000000, v56
    v_fmamk_f32 v59, v12, 0x40400000, v56
    v_fmamk_f32 v60, v12, 0x41000000, v56
    v_fmamk_f32 v61, v12, 0x41100000, v56
    v_fmamk_f32 v62, v12, 0x41200000, v56
    v_fmamk_f32 v63, v12, 0x41300000, v56
    v_fmamk_f32 v64, v12, 0x41800000, v56
    v_fmamk_f32 v65, v12, 0x41880000, v56
    v_fmamk_f32 v66, v12, 0x41900000, v56
    v_fmamk_f32 v67, v12, 0x41980000, v56
    v_fmamk_f32 v68, v12, 0x41c00000, v56
    v_fmamk_f32 v69, v12, 0x41c80000, v56
    v_fmamk_f32 v70, v12, 0x41d00000, v56
    v_fmamk_f32 v71, v12, 0x41d80000, v56
    v_sin_f32 v72, v56
    v_cos_f32 v56, v56
    v_sin_f32 v73, v57
    v_cos_f32 v57, v57
    v_sin_f32 v74, v58
    v_cos_f32 v58, v58
    v_sin_f32 v75, v59
    v_cos_f32 v59, v59
    v_sin_f32 v76, v60
    v_cos_f32 v60, v60
    v_sin_f32 v77, v61
    v_cos_f32 v61, v61
    v_sin_f32 v78, v62
    v_cos_f32 v62, v62
    v_sin_f32 v79, v63
    v_cos_f32 v63, v63
    v_sin_f32 v80, v64
    v_cos_f32 v64, v64
    v_sin_f32 v81, v65
    v_cos_f32 v65, v65
    v_sin_f32 v82, v66
    v_cos_f32 v66, v66
    v_sin_f32 v83, v67
    v_cos_f32 v67, v67
    v_sin_f32 v84, v68
    v_cos_f32 v68, v68
    v_sin_f32 v85, v69
    v_cos_f32 v69, v69
    v_sin_f32 v86, v70
    v_cos_f32 v70, v70
    v_sin_f32 v87, v71
    v_cos_f32 v71, v71
    s_lshr_b32 s44, s47, 5
    s_mul_i32 s44, s44, 896
    s_lshl2_add_u32 s47, s47, s44
    s_add_u32 s47, s47, 679936
    s_waitcnt vmcnt(0)
    s_mov_b64 exec, 1
    buffer_atomic_swap v4, off, s[16:19], s47 offset:0 sc1
    s_mov_b64 exec, -1
    s_cmp_ge_u32 s59, 29
    s_cbranch_scc1 L_sfin
    v_lshlrev_b32 v12, 2, v3
    s_lshl_b32 s47, s28, 10
    s_add_u32 s47, s47, 679936
    v_mov_b32 v20, 0
    s_mov_b64 exec, 0xffffffff
    buffer_atomic_or v20, v12, s[16:19], s47 offen sc0 sc1
    s_mov_b64 exec, -1
    v_and_b32 v8, 48, v2
    v_xor_b32 v8, v8, v0
    v_xor_b32 v9, 64, v8
    v_xor_b32 v10, 128, v8
    v_xor_b32 v11, 192, v8
    s_cmp_eq_u32 s59, 28
    s_cselect_b32 s35, 0, s59
    s_cselect_b32 s39, 2, 0
    s_or_b32 s44, s59, s28
    s_cselect_b32 s39, s39, 1
    s_cmp_ge_u32 s35, 14
    s_cselect_b32 s44, 14, 0
    s_cselect_b32 s45, 1, 0
    s_sub_u32 s44, s35, s44
    s_and_b32 s46, s28, 1
    s_lshl1_add_u32 s45, s46, s45
    s_lshr_b32 s46, s28, 1
    s_mul_i32 s37, s45, 56
    s_add_u32 s37, s37, s46
    s_cmp_ge_u32 s59, 14
    s_cselect_b32 s38, 2, 0
    s_add_u32 s38, s38, s59
    s_lshl_b32 s38, s38, 2
    s_add_u32 s38, s38, 589952
    s_lshl3_add_u32 s37, s44, s37
    s_cmp_ge_u32 s44, 7
    s_cselect_b32 s44, 52, 0
    s_sub_u32 s37, s37, s44
    s_lshl_b32 s37, s37, 7
    s_add_u32 s37, s37, 5242880
    s_lshl_b32 s34, s59, 16
    s_add_u32 s34, s34, s36
    s_add_u32 s34, s34, 3145728
    s_mov_b64 exec, 0xffffffff
    s_waitcnt vmcnt(0)
    s_movk_i32 s58, 0x4000
L_pt_14:
    v_cmp_ne_u32 vcc, v4, v20
    s_sub_u32 s58, s58, 1
    s_cbranch_vccz L_po_15
    s_cbranch_scc1 L_po_15
    s_sleep 2
    v_mov_b32 v20, 0
    buffer_atomic_or v20, v12, s[16:19], s47 offen sc0 sc1
    s_waitcnt vmcnt(0)
    s_branch L_pt_14
L_po_15:
    s_mov_b64 exec, -1
    s_add_u32 m0, s36, 0
    s_nop 0
    buffer_load_dwordx4 v8, s[16:19], s34 offen offset:0 sc1 lds
    buffer_load_dwordx4 v9, s[16:19], s34 offen offset:1024 sc1 lds
    buffer_load_dwordx4 v10, s[16:19], s34 offen offset:2048 sc1 lds
    buffer_load_dwordx4 v11, s[16:19], s34 offen offset:3072 sc1 lds
    s_add_u32 m0, s36, 4096
    s_add_u32 s34, s34, 4096
    buffer_load_dwordx4 v8, s[16:19], s34 offen offset:0 sc1 lds
    buffer_load_dwordx4 v9, s[16:19], s34 offen offset:1024 sc1 lds
    buffer_load_dwordx4 v10, s[16:19], s34 offen offset:2048 sc1 lds
    buffer_load_dwordx4 v11, s[16:19], s34 offen offset:3072 sc1 lds
    s_lshr_b32 s47, s35, 1
    s_lshl_b32 s47, s47, 5
    s_add_u32 s47, s47, s28
    s_lshl_b32 s47, s47, 5
    s_add_u32 s47, s47, 655360
    v_mov_b32 v20, 0
    s_mov_b64 exec, 0xff
    buffer_atomic_or v20, v12, s[16:19], s47 offen sc0 sc1
    s_mov_b64 exec, -1
    v_lshrrev_b32 v13, 1, v3
    v_and_b32 v14, 16, v0
    v_lshl_add_u32 v14, v6, 5, v14
    v_lshl_add_u32 v15, v13, 6, v14
    v_mul_u32_u24 v13, 28672, v13
    v_add_u32 v16, v13, v14
    v_and_b32 v13, 0xf0, v0
    v_lshl_add_u32 v13, v2, 8, v13
    s_lshl_b32 s44, s28, 4
    v_xor_b32 v17, s44, v13
    s_cmp_eq_u32 s59, 28
    s_cselect_b32 s44, 16, s44
    s_or_b32 s44, s44, 128
    v_xor_b32 v18, s44, v13
    v_add_u32 v19, 65536, v0
    s_lshl3_add_u32 s44, s35, s28
    s_lshl_b32 s34, s44, 13
    s_add_u32 s34, s34, 1048576
    s_mov_b64 exec, 0xff
    s_waitcnt vmcnt(0)
    s_movk_i32 s58, 0x4000
L_pt_16:
    v_cmp_ne_u32 vcc, v4, v20
    s_sub_u32 s58, s58, 1
    s_cbranch_vccz L_po_17
    s_cbranch_scc1 L_po_17
    s_sleep 2
    v_mov_b32 v20, 0
    buffer_atomic_or v20, v12, s[16:19], s47 offen sc0 sc1
    s_waitcnt vmcnt(0)
    s_branch L_pt_16
L_po_17:
    s_mov_b64 exec, -1
    s_barrier
    s_cmp_eq_u32 s59, 28
    s_cselect_b32 s44, s28, 0
    s_cmp_lg_u32 s44, 0
    s_cbranch_scc1 L_sfin
    buffer_load_dwordx4 v[24:27], v15, s[16:19], s34 offen offset:0 sc1
    buffer_load_dwordx4 v[28:31], v15, s[16:19], s34 offen offset:1024 sc1
    buffer_load_dwordx4 v[32:35], v15, s[16:19], s34 offen offset:2048 sc1
    buffer_load_dwordx4 v[36:39], v15, s[16:19], s34 offen offset:3072 sc1
    s_add_u32 s34, s34, 4096
    buffer_load_dwordx4 v[40:43], v15, s[16:19], s34 offen offset:0 sc1
    buffer_load_dwordx4 v[44:47], v15, s[16:19], s34 offen offset:1024 sc1
    buffer_load_dwordx4 v[48:51], v15, s[16:19], s34 offen offset:2048 sc1
    buffer_load_dwordx4 v[52:55], v15, s[16:19], s34 offen offset:3072 sc1
    ds_read_b128 v[184:187], v19 offset:0
    ds_read_b128 v[188:191], v19 offset:1024
    ds_read_b128 v[192:195], v19 offset:2048
    ds_read_b128 v[196:199], v19 offset:3072
    ds_read_b128 v[200:203], v19 offset:4096
    ds_read_b128 v[204:207], v19 offset:5120
    ds_read_b128 v[208:211], v19 offset:6144
    ds_read_b128 v[212:215], v19 offset:7168
    ds_read_b128 v[216:219], v19 offset:8192
    ds_read_b128 v[220:223], v19 offset:9216
    ds_read_b128 v[224:227], v19 offset:10240
    ds_read_b128 v[228:231], v19 offset:11264
    ds_read_b128 v[232:235], v19 offset:12288
    ds_read_b128 v[236:239], v19 offset:13312
    ds_read_b128 v[240:243], v19 offset:14336
    ds_read_b128 v[244:247], v19 offset:15360
    s_cmp_eq_u32 s39, 0
    s_cbranch_scc1 L_nz_18
    s_waitcnt vmcnt(0)
    s_cmp_eq_u32 s39, 2
    s_cselect_b32 exec_lo, -1, 0
    s_cselect_b32 exec_hi, 0, -1
    v_mov_b32 v24, 0
    v_mov_b32 v25, 0
    v_mov_b32 v26, 0
    v_mov_b32 v27, 0
    v_mov_b32 v28, 0
    v_mov_b32 v29, 0
    v_mov_b32 v30, 0
    v_mov_b32 v31, 0
    v_mov_b32 v32, 0
    v_mov_b32 v33, 0
    v_mov_b32 v34, 0
    v_mov_b32 v35, 0
    v_mov_b32 v36, 0
    v_mov_b32 v37, 0
    v_mov_b32 v38, 0
    v_mov_b32 v39, 0
    v_mov_b32 v40, 0
    v_mov_b32 v41, 0
    v_mov_b32 v42, 0
    v_mov_b32 v43, 0
    v_mov_b32 v44, 0
    v_mov_b32 v45, 0
    v_mov_b32 v46, 0
    v_mov_b32 v47, 0
    v_mov_b32 v48, 0
    v_mov_b32 v49, 0
    v_mov_b32 v50, 0
    v_mov_b32 v51, 0
    v_mov_b32 v52, 0
    v_mov_b32 v53, 0
    v_mov_b32 v54, 0
    v_mov_b32 v55, 0
    s_mov_b64 exec, -1
L_nz_18:
    s_waitcnt vmcnt(7) lgkmcnt(15)
    v_mfma_f32_32x32x16_bf16 v[88:103], v[24:27], v[184:187], 0
    s_waitcnt lgkmcnt(14)
    v_mfma_f32_32x32x16_bf16 v[104:119], v[24:27], v[188:191], 0
    s_waitcnt vmcnt(6) lgkmcnt(13)
    v_mfma_f32_32x32x16_bf16 v[88:103], v[28:31], v[192:195], v[88:103]
    s_waitcnt lgkmcnt(12)
    v_mfma_f32_32x32x16_bf16 v[104:119], v[28:31], v[196:199], v[104:119]
    s_waitcnt vmcnt(5) lgkmcnt(11)
    v_mfma_f32_32x32x16_bf16 v[88:103], v[32:35], v[200:203], v[88:103]
    s_waitcnt lgkmcnt(10)
    v_mfma_f32_32x32x16_bf16 v[104:119], v[32:35], v[204:207], v[104:119]
    s_waitcnt vmcnt(4) lgkmcnt(9)
    v_mfma_f32_32x32x16_bf16 v[88:103], v[36:39], v[208:211], v[88:103]
    s_waitcnt lgkmcnt(8)
    v_mfma_f32_32x32x16_bf16 v[104:119], v[36:39], v[212:215], v[104:119]
    s_waitcnt vmcnt(3) lgkmcnt(7)
    v_mfma_f32_32x32x16_bf16 v[120:135], v[40:43], v[216:219], 0
    ds_read_b128 v[184:187], v19 offset:16384
    ds_read_b128 v[188:191], v19 offset:17408
    s_nop 5
    v_mul_f32 v248, v88, v56
    s_nop 0
    v_mul_f32 v250, v104, v56
    v_mul_f32 v249, v89, v57
    v_mul_f32 v251, v105, v57
    v_fma_f32 v248, v104, v72, v248
    v_fma_f32 v250, -v88, v72, v250
    v_fma_f32 v249, v105, v73, v249
    s_waitcnt lgkmcnt(8)
    v_mfma_f32_32x32x16_bf16 v[136:151], v[40:43], v[220:223], 0
    ds_read_b128 v[192:195], v19 offset:18432
    ds_read_b128 v[196:199], v19 offset:19456
    v_fma_f32 v251, -v89, v73, v251
    v_cvt_pk_bf16_f32 v152, v248, v249
    v_cvt_pk_bf16_f32 v160, v250, v251
    v_mul_f32 v248, v90, v58
    v_mul_f32 v250, v106, v58
    v_mul_f32 v249, v91, v59
    v_mul_f32 v251, v107, v59
    v_fma_f32 v248, v106, v74, v248
    v_fma_f32 v250, -v90, v74, v250
    v_fma_f32 v249, v107, v75, v249
    v_fma_f32 v251, -v91, v75, v251
    s_waitcnt vmcnt(2) lgkmcnt(9)
    v_mfma_f32_32x32x16_bf16 v[120:135], v[44:47], v[224:227], v[120:135]
    ds_read_b128 v[200:203], v19 offset:20480
    ds_read_b128 v[204:207], v19 offset:21504
    v_cvt_pk_bf16_f32 v153, v248, v249
    v_cvt_pk_bf16_f32 v161, v250, v251
    v_mul_f32 v248, v92, v60
    v_mul_f32 v250, v108, v60
    v_mul_f32 v249, v93, v61
    v_mul_f32 v251, v109, v61
    v_fma_f32 v248, v108, v76, v248
    v_fma_f32 v250, -v92, v76, v250
    v_fma_f32 v249, v109, v77, v249
    v_fma_f32 v251, -v93, v77, v251
    v_cvt_pk_bf16_f32 v154, v248, v249
    s_waitcnt lgkmcnt(10)
    v_mfma_f32_32x32x16_bf16 v[136:151], v[44:47], v[228:231], v[136:151]
    v_cvt_pk_bf16_f32 v162, v250, v251
    v_mul_f32 v248, v94, v62
    v_mul_f32 v250, v110, v62
    v_mul_f32 v249, v95, v63
    v_mul_f32 v251, v111, v63
    v_fma_f32 v248, v110, v78, v248
    v_fma_f32 v250, -v94, v78, v250
    v_fma_f32 v249, v111, v79, v249
    v_fma_f32 v251, -v95, v79, v251
    v_cvt_pk_bf16_f32 v155, v248, v249
    v_cvt_pk_bf16_f32 v163, v250, v251
    s_waitcnt vmcnt(1) lgkmcnt(9)
    v_mfma_f32_32x32x16_bf16 v[120:135], v[48:51], v[232:235], v[120:135]
    v_mul_f32 v248, v96, v64
    v_mul_f32 v250, v112, v64
    v_mul_f32 v249, v97, v65
    v_mul_f32 v251, v113, v65
    v_fma_f32 v248, v112, v80, v248
    v_fma_f32 v250, -v96, v80, v250
    v_fma_f32 v249, v113, v81, v249
    v_fma_f32 v251, -v97, v81, v251
    v_cvt_pk_bf16_f32 v156, v248, v249
    v_cvt_pk_bf16_f32 v164, v250, v251
    v_mul_f32 v248, v98, v66
    s_waitcnt lgkmcnt(8)
    v_mfma_f32_32x32x16_bf16 v[136:151], v[48:51], v[236:239], v[136:151]
    v_mul_f32 v250, v114, v66
    v_mul_f32 v249, v99, v67
    v_mul_f32 v251, v115, v67
    v_fma_f32 v248, v114, v82, v248
    v_fma_f32 v250, -v98, v82, v250
    v_fma_f32 v249, v115, v83, v249
    v_fma_f32 v251, -v99, v83, v251
    v_cvt_pk_bf16_f32 v157, v248, v249
    v_cvt_pk_bf16_f32 v165, v250, v251
    v_mul_f32 v248, v100, v68
    v_mul_f32 v250, v116, v68
    s_waitcnt vmcnt(0) lgkmcnt(7)
    v_mfma_f32_32x32x16_bf16 v[120:135], v[52:55], v[240:243], v[120:135]
    v_mul_f32 v249, v101, v69
    v_mul_f32 v251, v117, v69
    v_fma_f32 v248, v116, v84, v248
    v_fma_f32 v250, -v100, v84, v250
    v_fma_f32 v249, v117, v85, v249
    v_fma_f32 v251, -v101, v85, v251
    v_cvt_pk_bf16_f32 v158, v248, v249
    v_cvt_pk_bf16_f32 v166, v250, v251
    v_mul_f32 v248, v102, v70
    v_mul_f32 v250, v118, v70
    v_mul_f32 v249, v103, v71
    s_waitcnt lgkmcnt(6)
    v_mfma_f32_32x32x16_bf16 v[136:151], v[52:55], v[244:247], v[136:151]
    v_mul_f32 v251, v119, v71
    v_fma_f32 v248, v118, v86, v248
    v_fma_f32 v250, -v102, v86, v250
    v_fma_f32 v249, v119, v87, v249
    v_fma_f32 v251, -v103, v87, v251
    v_cvt_pk_bf16_f32 v159, v248, v249
    v_cvt_pk_bf16_f32 v167, v250, v251
    s_waitcnt lgkmcnt(5)
    v_mfma_f32_32x32x16_bf16 v[88:103], v[184:187], v[152:155], 0
    ds_read_b128 v[216:219], v19 offset:22528
    ds_read_b128 v[220:223], v19 offset:23552
    v_mul_f32 v248, v120, v56
    v_mul_f32 v250, v136, v56
    v_mul_f32 v249, v121, v57
    v_mul_f32 v251, v137, v57
    v_fma_f32 v248, v136, v72, v248
    v_fma_f32 v250, -v120, v72, v250
    v_fma_f32 v249, v137, v73, v249
    v_mfma_f32_32x32x16_bf16 v[104:119], v[184:187], v[160:163], 0
    ds_read_b128 v[224:227], v19 offset:24576
    ds_read_b128 v[228:231], v19 offset:25600
    v_fma_f32 v251, -v121, v73, v251
    v_cvt_pk_bf16_f32 v168, v248, v249
    v_cvt_pk_bf16_f32 v176, v250, v251
    v_mul_f32 v248, v122, v58
    v_mul_f32 v250, v138, v58
    v_mul_f32 v249, v123, v59
    v_mul_f32 v251, v139, v59
    v_fma_f32 v248, v138, v74, v248
    v_fma_f32 v250, -v122, v74, v250
    v_fma_f32 v249, v139, v75, v249
    v_fma_f32 v251, -v123, v75, v251
    s_waitcnt lgkmcnt(8)
    v_mfma_f32_32x32x16_bf16 v[88:103], v[188:191], v[160:163], v[88:103]
    ds_read_b128 v[232:235], v19 offset:26624
    ds_read_b128 v[236:239], v19 offset:27648
    v_cvt_pk_bf16_f32 v169, v248, v249
    v_cvt_pk_bf16_f32 v177, v250, v251
    v_mul_f32 v248, v124, v60
    v_mul_f32 v250, v140, v60
    v_mul_f32 v249, v125, v61
    v_mul_f32 v251, v141, v61
    v_fma_f32 v248, v140, v76, v248
    v_fma_f32 v250, -v124, v76, v250
    v_fma_f32 v249, v141, v77, v249
    v_fma_f32 v251, -v125, v77, v251
    v_cvt_pk_bf16_f32 v170, v248, v249
    s_waitcnt lgkmcnt(9)
    v_mfma_f32_32x32x16_bf16 v[104:119], v[192:195], v[152:155], v[104:119]
    ds_read_b128 v[24:27], v17 offset:0
    ds_read_b128 v[28:31], v17 offset:16384
    v_cvt_pk_bf16_f32 v178, v250, v251
    v_mul_f32 v248, v126, v62
    v_mul_f32 v250, v142, v62
    v_mul_f32 v249, v127, v63
    v_mul_f32 v251, v143, v63
    v_fma_f32 v248, v142, v78, v248
    v_fma_f32 v250, -v126, v78, v250
    v_fma_f32 v249, v143, v79, v249
    v_fma_f32 v251, -v127, v79, v251
    v_cvt_pk_bf16_f32 v171, v248, v249
    v_cvt_pk_bf16_f32 v179, v250, v251
    s_waitcnt lgkmcnt(10)
    v_mfma_f32_32x32x16_bf16 v[88:103], v[196:199], v[156:159], v[88:103]
    ds_read_b128 v[32:35], v17 offset:32768
    ds_read_b128 v[36:39], v17 offset:49152
    v_mul_f32 v248, v128, v64
    v_mul_f32 v250, v144, v64
    v_mul_f32 v249, v129, v65
    v_mul_f32 v251, v145, v65
    v_fma_f32 v248, v144, v80, v248
    v_fma_f32 v250, -v128, v80, v250
    v_fma_f32 v249, v145, v81, v249
    v_fma_f32 v251, -v129, v81, v251
    v_cvt_pk_bf16_f32 v172, v248, v249
    v_cvt_pk_bf16_f32 v180, v250, v251
    v_mul_f32 v248, v130, v66
    v_mfma_f32_32x32x16_bf16 v[104:119], v[196:199], v[164:167], v[104:119]
    v_mul_f32 v250, v146, v66
    v_mul_f32 v249, v131, v67
    v_mul_f32 v251, v147, v67
    v_fma_f32 v248, v146, v82, v248
    v_fma_f32 v250, -v130, v82, v250
    v_fma_f32 v249, v147, v83, v249
    v_fma_f32 v251, -v131, v83, v251
    v_cvt_pk_bf16_f32 v173, v248, v249
    v_cvt_pk_bf16_f32 v181, v250, v251
    v_mul_f32 v248, v132, v68
    v_mul_f32 v250, v148, v68
    s_waitcnt lgkmcnt(11)
    v_mfma_f32_32x32x16_bf16 v[88:103], v[200:203], v[164:167], v[88:103]
    v_mul_f32 v249, v133, v69
    v_mul_f32 v251, v149, v69
    v_fma_f32 v248, v148, v84, v248
    v_fma_f32 v250, -v132, v84, v250
    v_fma_f32 v249, v149, v85, v249
    v_fma_f32 v251, -v133, v85, v251
    v_cvt_pk_bf16_f32 v174, v248, v249
    v_cvt_pk_bf16_f32 v182, v250, v251
    v_mul_f32 v248, v134, v70
    v_mul_f32 v250, v150, v70
    v_mul_f32 v249, v135, v71
    s_waitcnt lgkmcnt(10)
    v_mfma_f32_32x32x16_bf16 v[104:119], v[204:207], v[156:159], v[104:119]
    v_mul_f32 v251, v151, v71
    v_fma_f32 v248, v150, v86, v248
    v_fma_f32 v250, -v134, v86, v250
    v_fma_f32 v249, v151, v87, v249
    v_fma_f32 v251, -v135, v87, v251
    v_cvt_pk_bf16_f32 v175, v248, v249
    v_cvt_pk_bf16_f32 v183, v250, v251
    s_waitcnt lgkmcnt(9)
    v_mfma_f32_32x32x16_bf16 v[120:135], v[216:219], v[168:171], 0
    ds_read_b128 v[40:43], v18 offset:0
    ds_read_b128 v[44:47], v18 offset:16384
    s_waitcnt lgkmcnt(5)
    v_lshlrev_b32 v252, 16, v24
    v_and_b32 v253, 0xffff0000, v24
    v_lshlrev_b32 v254, 16, v26
    v_and_b32 v255, 0xffff0000, v26
    v_mul_f32 v248, v88, v252
    v_mul_f32 v250, v104, v252
    v_mul_f32 v249, v89, v253
    v_mfma_f32_32x32x16_bf16 v[136:151], v[216:219], v[176:179], 0
    ds_read_b128 v[48:51], v18 offset:32768
    ds_read_b128 v[52:55], v18 offset:49152
    v_mul_f32 v251, v105, v253
    v_fma_f32 v248, -v104, v254, v248
    v_fma_f32 v250, v88, v254, v250
    v_fma_f32 v249, -v105, v255, v249
    v_fma_f32 v251, v89, v255, v251
    v_cvt_pk_bf16_f32 v152, v248, v249
    v_cvt_pk_bf16_f32 v160, v250, v251
    v_lshlrev_b32 v252, 16, v25
    v_and_b32 v253, 0xffff0000, v25
    v_lshlrev_b32 v254, 16, v27
    v_and_b32 v255, 0xffff0000, v27
    v_mfma_f32_32x32x16_bf16 v[120:135], v[220:223], v[176:179], v[120:135]
    v_mul_f32 v248, v90, v252
    v_mul_f32 v250, v106, v252
    v_mul_f32 v249, v91, v253
    v_mul_f32 v251, v107, v253
    v_fma_f32 v248, -v106, v254, v248
    v_fma_f32 v250, v90, v254, v250
    v_fma_f32 v249, -v107, v255, v249
    v_fma_f32 v251, v91, v255, v251
    v_cvt_pk_bf16_f32 v153, v248, v249
    v_cvt_pk_bf16_f32 v161, v250, v251
    s_waitcnt lgkmcnt(6)
    v_lshlrev_b32 v252, 16, v28
    v_mfma_f32_32x32x16_bf16 v[136:151], v[224:227], v[168:171], v[136:151]
    v_and_b32 v253, 0xffff0000, v28
    v_lshlrev_b32 v254, 16, v30
    v_and_b32 v255, 0xffff0000, v30
    v_mul_f32 v248, v92, v252
    v_mul_f32 v250, v108, v252
    v_mul_f32 v249, v93, v253
    v_mul_f32 v251, v109, v253
    v_fma_f32 v248, -v108, v254, v248
    v_fma_f32 v250, v92, v254, v250
    v_fma_f32 v249, -v109, v255, v249
    v_fma_f32 v251, v93, v255, v251
    v_mfma_f32_32x32x16_bf16 v[120:135], v[228:231], v[172:175], v[120:135]
    v_cvt_pk_bf16_f32 v154, v248, v249
    v_cvt_pk_bf16_f32 v162, v250, v251
    v_lshlrev_b32 v252, 16, v29
    v_and_b32 v253, 0xffff0000, v29
    v_lshlrev_b32 v254, 16, v31
    v_and_b32 v255, 0xffff0000, v31
    v_mul_f32 v248, v94, v252
    v_mul_f32 v250, v110, v252
    v_mul_f32 v249, v95, v253
    v_mul_f32 v251, v111, v253
    v_fma_f32 v248, -v110, v254, v248
    v_mfma_f32_32x32x16_bf16 v[136:151], v[228:231], v[180:183], v[136:151]
    v_fma_f32 v250, v94, v254, v250
    v_fma_f32 v249, -v111, v255, v249
    v_fma_f32 v251, v95, v255, v251
    v_cvt_pk_bf16_f32 v155, v248, v249
    v_cvt_pk_bf16_f32 v163, v250, v251
    s_waitcnt lgkmcnt(5)
    v_lshlrev_b32 v252, 16, v32
    v_and_b32 v253, 0xffff0000, v32
    v_lshlrev_b32 v254, 16, v34
    v_and_b32 v255, 0xffff0000, v34
    v_mul_f32 v248, v96, v252
    v_mul_f32 v250, v112, v252
    v_mfma_f32_32x32x16_bf16 v[120:135], v[232:235], v[180:183], v[120:135]
    v_mul_f32 v249, v97, v253
    v_mul_f32 v251, v113, v253
    v_fma_f32 v248, -v112, v254, v248
    v_fma_f32 v250, v96, v254, v250
    v_fma_f32 v249, -v113, v255, v249
    v_fma_f32 v251, v97, v255, v251
    v_cvt_pk_bf16_f32 v156, v248, v249
    v_cvt_pk_bf16_f32 v164, v250, v251
    v_lshlrev_b32 v252, 16, v33
    v_and_b32 v253, 0xffff0000, v33
    v_lshlrev_b32 v254, 16, v35
    v_mfma_f32_32x32x16_bf16 v[136:151], v[236:239], v[172:175], v[136:151]
    v_and_b32 v255, 0xffff0000, v35
    v_mul_f32 v248, v98, v252
    v_mul_f32 v250, v114, v252
    v_mul_f32 v249, v99, v253
    v_mul_f32 v251, v115, v253
    v_fma_f32 v248, -v114, v254, v248
    v_fma_f32 v250, v98, v254, v250
    v_fma_f32 v249, -v115, v255, v249
    v_fma_f32 v251, v99, v255, v251
    v_cvt_pk_bf16_f32 v157, v248, v249
    v_cvt_pk_bf16_f32 v165, v250, v251
    s_waitcnt lgkmcnt(4)
    v_lshlrev_b32 v252, 16, v36
    v_and_b32 v253, 0xffff0000, v36
    v_lshlrev_b32 v254, 16, v38
    v_and_b32 v255, 0xffff0000, v38
    v_mul_f32 v248, v100, v252
    v_mul_f32 v250, v116, v252
    v_mul_f32 v249, v101, v253
    v_mul_f32 v251, v117, v253
    v_fma_f32 v248, -v116, v254, v248
    v_fma_f32 v250, v100, v254, v250
    v_fma_f32 v249, -v117, v255, v249
    v_fma_f32 v251, v101, v255, v251
    v_cvt_pk_bf16_f32 v158, v248, v249
    v_cvt_pk_bf16_f32 v166, v250, v251
    v_lshlrev_b32 v252, 16, v37
    v_and_b32 v253, 0xffff0000, v37
    v_lshlrev_b32 v254, 16, v39
    v_and_b32 v255, 0xffff0000, v39
    v_mul_f32 v248, v102, v252
    v_mul_f32 v250, v118, v252
    v_mul_f32 v249, v103, v253
    v_mul_f32 v251, v119, v253
    v_fma_f32 v248, -v118, v254, v248
    v_fma_f32 v250, v102, v254, v250
    v_fma_f32 v249, -v119, v255, v249
    v_fma_f32 v251, v103, v255, v251
    v_cvt_pk_bf16_f32 v159, v248, v249
    v_cvt_pk_bf16_f32 v167, v250, v251
    v_mfma_f32_32x32x16_bf16 v[88:103], v[152:155], v[184:187], 0
    ds_read_b128 v[216:219], v19 offset:28672
    ds_read_b128 v[220:223], v19 offset:29696
    s_waitcnt lgkmcnt(5)
    v_lshlrev_b32 v252, 16, v40
    v_and_b32 v253, 0xffff0000, v40
    v_lshlrev_b32 v254, 16, v42
    v_and_b32 v255, 0xffff0000, v42
    v_mul_f32 v248, v120, v252
    v_mul_f32 v250, v136, v252
    v_mul_f32 v249, v121, v253
    v_mfma_f32_32x32x16_bf16 v[104:119], v[160:163], v[184:187], 0
    ds_read_b128 v[224:227], v19 offset:30720
    ds_read_b128 v[228:231], v19 offset:31744
    v_mul_f32 v251, v137, v253
    v_fma_f32 v248, -v136, v254, v248
    v_fma_f32 v250, v120, v254, v250
    v_fma_f32 v249, -v137, v255, v249
    v_fma_f32 v251, v121, v255, v251
    v_cvt_pk_bf16_f32 v168, v248, v249
    v_cvt_pk_bf16_f32 v176, v250, v251
    v_lshlrev_b32 v252, 16, v41
    v_and_b32 v253, 0xffff0000, v41
    v_lshlrev_b32 v254, 16, v43
    v_and_b32 v255, 0xffff0000, v43
    v_mfma_f32_32x32x16_bf16 v[88:103], v[160:163], v[192:195], v[88:103]
    ds_read_b128 v[232:235], v19 offset:32768
    ds_read_b128 v[236:239], v19 offset:33792
    v_mul_f32 v248, v122, v252
    v_mul_f32 v250, v138, v252
    v_mul_f32 v249, v123, v253
    v_mul_f32 v251, v139, v253
    v_fma_f32 v248, -v138, v254, v248
    v_fma_f32 v250, v122, v254, v250
    v_fma_f32 v249, -v139, v255, v249
    v_fma_f32 v251, v123, v255, v251
    v_cvt_pk_bf16_f32 v169, v248, v249
    v_cvt_pk_bf16_f32 v177, v250, v251
    s_waitcnt lgkmcnt(8)
    v_lshlrev_b32 v252, 16, v44
    v_mfma_f32_32x32x16_bf16 v[104:119], v[152:155], v[188:191], v[104:119]
    v_and_b32 v253, 0xffff0000, v44
    v_lshlrev_b32 v254, 16, v46
    v_and_b32 v255, 0xffff0000, v46
    v_mul_f32 v248, v124, v252
    v_mul_f32 v250, v140, v252
    v_mul_f32 v249, v125, v253
    v_mul_f32 v251, v141, v253
    v_fma_f32 v248, -v140, v254, v248
    v_fma_f32 v250, v124, v254, v250
    v_fma_f32 v249, -v141, v255, v249
    v_fma_f32 v251, v125, v255, v251
    v_mfma_f32_32x32x16_bf16 v[88:103], v[156:159], v[196:199], v[88:103]
    v_cvt_pk_bf16_f32 v170, v248, v249
    v_cvt_pk_bf16_f32 v178, v250, v251
    v_lshlrev_b32 v252, 16, v45
    v_and_b32 v253, 0xffff0000, v45
    v_lshlrev_b32 v254, 16, v47
    v_and_b32 v255, 0xffff0000, v47
    v_mul_f32 v248, v126, v252
    v_mul_f32 v250, v142, v252
    v_mul_f32 v249, v127, v253
    v_mul_f32 v251, v143, v253
    v_fma_f32 v248, -v142, v254, v248
    v_mfma_f32_32x32x16_bf16 v[104:119], v[164:167], v[196:199], v[104:119]
    v_fma_f32 v250, v126, v254, v250
    v_fma_f32 v249, -v143, v255, v249
    v_fma_f32 v251, v127, v255, v251
    v_cvt_pk_bf16_f32 v171, v248, v249
    v_cvt_pk_bf16_f32 v179, v250, v251
    s_waitcnt lgkmcnt(7)
    v_lshlrev_b32 v252, 16, v48
    v_and_b32 v253, 0xffff0000, v48
    v_lshlrev_b32 v254, 16, v50
    v_and_b32 v255, 0xffff0000, v50
    v_mul_f32 v248, v128, v252
    v_mul_f32 v250, v144, v252
    v_mfma_f32_32x32x16_bf16 v[88:103], v[164:167], v[204:207], v[88:103]
    v_mul_f32 v249, v129, v253
    v_mul_f32 v251, v145, v253
    v_fma_f32 v248, -v144, v254, v248
    v_fma_f32 v250, v128, v254, v250
    v_fma_f32 v249, -v145, v255, v249
    v_fma_f32 v251, v129, v255, v251
    v_cvt_pk_bf16_f32 v172, v248, v249
    v_cvt_pk_bf16_f32 v180, v250, v251
    v_lshlrev_b32 v252, 16, v49
    v_and_b32 v253, 0xffff0000, v49
    v_lshlrev_b32 v254, 16, v51
    v_mfma_f32_32x32x16_bf16 v[104:119], v[156:159], v[200:203], v[104:119]
    v_and_b32 v255, 0xffff0000, v51
    v_mul_f32 v248, v130, v252
    v_mul_f32 v250, v146, v252
    v_mul_f32 v249, v131, v253
    v_mul_f32 v251, v147, v253
    v_fma_f32 v248, -v146, v254, v248
    v_fma_f32 v250, v130, v254, v250
    v_fma_f32 v249, -v147, v255, v249
    v_fma_f32 v251, v131, v255, v251
    v_cvt_pk_bf16_f32 v173, v248, v249
    v_cvt_pk_bf16_f32 v181, v250, v251
    s_waitcnt lgkmcnt(6)
    v_lshlrev_b32 v252, 16, v52
    v_and_b32 v253, 0xffff0000, v52
    v_lshlrev_b32 v254, 16, v54
    v_and_b32 v255, 0xffff0000, v54
    v_mul_f32 v248, v132, v252
    v_mul_f32 v250, v148, v252
    v_mul_f32 v249, v133, v253
    v_mul_f32 v251, v149, v253
    v_fma_f32 v248, -v148, v254, v248
    v_fma_f32 v250, v132, v254, v250
    v_fma_f32 v249, -v149, v255, v249
    v_fma_f32 v251, v133, v255, v251
    v_cvt_pk_bf16_f32 v174, v248, v249
    v_cvt_pk_bf16_f32 v182, v250, v251
    v_lshlrev_b32 v252, 16, v53
    v_and_b32 v253, 0xffff0000, v53
    v_lshlrev_b32 v254, 16, v55
    v_and_b32 v255, 0xffff0000, v55
    v_mul_f32 v248, v134, v252
    v_mul_f32 v250, v150, v252
    v_mul_f32 v249, v135, v253
    v_mul_f32 v251, v151, v253
    v_fma_f32 v248, -v150, v254, v248
    v_fma_f32 v250, v134, v254, v250
    v_fma_f32 v249, -v151, v255, v249
    v_fma_f32 v251, v135, v255, v251
    v_cvt_pk_bf16_f32 v175, v248, v249
    v_cvt_pk_bf16_f32 v183, v250, v251
    s_waitcnt lgkmcnt(5)
    v_mfma_f32_32x32x16_bf16 v[120:135], v[168:171], v[216:219], 0
    v_mul_f32 v248, v88, v56
    v_mul_f32 v250, v104, v56
    v_mul_f32 v249, v89, v57
    v_mul_f32 v251, v105, v57
    v_fma_f32 v248, -v104, v72, v248
    v_fma_f32 v250, v88, v72, v250
    v_fma_f32 v249, -v105, v73, v249
    v_mfma_f32_32x32x16_bf16 v[136:151], v[176:179], v[216:219], 0
    v_fma_f32 v251, v89, v73, v251
    v_cvt_pk_bf16_f32 v152, v248, v249
    v_cvt_pk_bf16_f32 v160, v250, v251
    v_mul_f32 v248, v90, v58
    v_mul_f32 v250, v106, v58
    v_mul_f32 v249, v91, v59
    v_mul_f32 v251, v107, v59
    v_fma_f32 v248, -v106, v74, v248
    v_fma_f32 v250, v90, v74, v250
    v_fma_f32 v249, -v107, v75, v249
    v_fma_f32 v251, v91, v75, v251
    s_waitcnt lgkmcnt(3)
    v_mfma_f32_32x32x16_bf16 v[120:135], v[176:179], v[224:227], v[120:135]
    v_cvt_pk_bf16_f32 v153, v248, v249
    v_cvt_pk_bf16_f32 v161, v250, v251
    v_mul_f32 v248, v92, v60
    v_mul_f32 v250, v108, v60
    v_mul_f32 v249, v93, v61
    v_mul_f32 v251, v109, v61
    v_fma_f32 v248, -v108, v76, v248
    v_fma_f32 v250, v92, v76, v250
    v_fma_f32 v249, -v109, v77, v249
    v_fma_f32 v251, v93, v77, v251
    v_cvt_pk_bf16_f32 v154, v248, v249
    v_mfma_f32_32x32x16_bf16 v[136:151], v[168:171], v[220:223], v[136:151]
    v_cvt_pk_bf16_f32 v162, v250, v251
    v_mul_f32 v248, v94, v62
    v_mul_f32 v250, v110, v62
    v_mul_f32 v249, v95, v63
    v_mul_f32 v251, v111, v63
    v_fma_f32 v248, -v110, v78, v248
    v_fma_f32 v250, v94, v78, v250
    v_fma_f32 v249, -v111, v79, v249
    v_fma_f32 v251, v95, v79, v251
    v_cvt_pk_bf16_f32 v155, v248, v249
    v_cvt_pk_bf16_f32 v163, v250, v251
    s_waitcnt lgkmcnt(2)
    v_mfma_f32_32x32x16_bf16 v[120:135], v[172:175], v[228:231], v[120:135]
    v_mul_f32 v248, v96, v64
    v_mul_f32 v250, v112, v64
    v_mul_f32 v249, v97, v65
    v_mul_f32 v251, v113, v65
    v_fma_f32 v248, -v112, v80, v248
    v_fma_f32 v250, v96, v80, v250
    v_fma_f32 v249, -v113, v81, v249
    v_fma_f32 v251, v97, v81, v251
    v_cvt_pk_bf16_f32 v156, v248, v249
    v_cvt_pk_bf16_f32 v164, v250, v251
    v_mul_f32 v248, v98, v66
    v_mfma_f32_32x32x16_bf16 v[136:151], v[180:183], v[228:231], v[136:151]
    v_mul_f32 v250, v114, v66
    v_mul_f32 v249, v99, v67
    v_mul_f32 v251, v115, v67
    v_fma_f32 v248, -v114, v82, v248
    v_fma_f32 v250, v98, v82, v250
    v_fma_f32 v249, -v115, v83, v249
    v_fma_f32 v251, v99, v83, v251
    v_cvt_pk_bf16_f32 v157, v248, v249
    v_cvt_pk_bf16_f32 v165, v250, v251
    v_mul_f32 v248, v100, v68
    v_mul_f32 v250, v116, v68
    s_waitcnt lgkmcnt(0)
    v_mfma_f32_32x32x16_bf16 v[120:135], v[180:183], v[236:239], v[120:135]
    v_mul_f32 v249, v101, v69
    v_mul_f32 v251, v117, v69
    v_fma_f32 v248, -v116, v84, v248
    v_fma_f32 v250, v100, v84, v250
    v_fma_f32 v249, -v117, v85, v249
    v_fma_f32 v251, v101, v85, v251
    v_cvt_pk_bf16_f32 v158, v248, v249
    v_cvt_pk_bf16_f32 v166, v250, v251
    v_mul_f32 v248, v102, v70
    v_mul_f32 v250, v118, v70
    v_mul_f32 v249, v103, v71
    v_mfma_f32_32x32x16_bf16 v[136:151], v[172:175], v[232:235], v[136:151]
    v_mul_f32 v251, v119, v71
    v_fma_f32 v248, -v118, v86, v248
    v_fma_f32 v250, v102, v86, v250
    v_fma_f32 v249, -v119, v87, v249
    v_fma_f32 v251, v103, v87, v251
    v_cvt_pk_bf16_f32 v159, v248, v249
    v_cvt_pk_bf16_f32 v167, v250, v251
    v_mfma_f32_32x32x16_bf16 v[88:103], v[184:187], v[152:155], 0
    ds_read_b128 v[216:219], v19 offset:34816
    ds_read_b128 v[220:223], v19 offset:35840
    v_mul_f32 v248, v120, v56
    s_nop 0
    v_mul_f32 v250, v136, v56
    v_mul_f32 v249, v121, v57
    v_mul_f32 v251, v137, v57
    v_fma_f32 v248, -v136, v72, v248
    v_fma_f32 v250, v120, v72, v250
    v_fma_f32 v249, -v137, v73, v249
    v_mfma_f32_32x32x16_bf16 v[104:119], v[184:187], v[160:163], 0
    ds_read_b128 v[224:227], v19 offset:36864
    ds_read_b128 v[228:231], v19 offset:37888
    v_fma_f32 v251, v121, v73, v251
    v_cvt_pk_bf16_f32 v168, v248, v249
    v_cvt_pk_bf16_f32 v176, v250, v251
    v_mul_f32 v248, v122, v58
    v_mul_f32 v250, v138, v58
    v_mul_f32 v249, v123, v59
    v_mul_f32 v251, v139, v59
    v_fma_f32 v248, -v138, v74, v248
    v_fma_f32 v250, v122, v74, v250
    v_fma_f32 v249, -v139, v75, v249
    v_fma_f32 v251, v123, v75, v251
    v_mfma_f32_32x32x16_bf16 v[88:103], v[192:195], v[160:163], v[88:103]
    ds_read_b128 v[232:235], v19 offset:38912
    ds_read_b128 v[236:239], v19 offset:39936
    v_cvt_pk_bf16_f32 v169, v248, v249
    v_cvt_pk_bf16_f32 v177, v250, v251
    v_mul_f32 v248, v124, v60
    v_mul_f32 v250, v140, v60
    v_mul_f32 v249, v125, v61
    v_mul_f32 v251, v141, v61
    v_fma_f32 v248, -v140, v76, v248
    v_fma_f32 v250, v124, v76, v250
    v_fma_f32 v249, -v141, v77, v249
    v_fma_f32 v251, v125, v77, v251
    v_cvt_pk_bf16_f32 v170, v248, v249
    v_mfma_f32_32x32x16_bf16 v[104:119], v[188:191], v[152:155], v[104:119]
    v_cvt_pk_bf16_f32 v178, v250, v251
    v_mul_f32 v248, v126, v62
    v_mul_f32 v250, v142, v62
    v_mul_f32 v249, v127, v63
    v_mul_f32 v251, v143, v63
    v_fma_f32 v248, -v142, v78, v248
    v_fma_f32 v250, v126, v78, v250
    v_fma_f32 v249, -v143, v79, v249
    v_fma_f32 v251, v127, v79, v251
    v_cvt_pk_bf16_f32 v171, v248, v249
    v_cvt_pk_bf16_f32 v179, v250, v251
    v_mfma_f32_32x32x16_bf16 v[88:103], v[196:199], v[156:159], v[88:103]
    v_mul_f32 v248, v128, v64
    v_mul_f32 v250, v144, v64
    v_mul_f32 v249, v129, v65
    v_mul_f32 v251, v145, v65
    v_fma_f32 v248, -v144, v80, v248
    v_fma_f32 v250, v128, v80, v250
    v_fma_f32 v249, -v145, v81, v249
    v_fma_f32 v251, v129, v81, v251
    v_cvt_pk_bf16_f32 v172, v248, v249
    v_cvt_pk_bf16_f32 v180, v250, v251
    v_mul_f32 v248, v130, v66
    v_mfma_f32_32x32x16_bf16 v[104:119], v[196:199], v[164:167], v[104:119]
    v_mul_f32 v250, v146, v66
    v_mul_f32 v249, v131, v67
    v_mul_f32 v251, v147, v67
    v_fma_f32 v248, -v146, v82, v248
    v_fma_f32 v250, v130, v82, v250
    v_fma_f32 v249, -v147, v83, v249
    v_fma_f32 v251, v131, v83, v251
    v_cvt_pk_bf16_f32 v173, v248, v249
    v_cvt_pk_bf16_f32 v181, v250, v251
    v_mul_f32 v248, v132, v68
    v_mul_f32 v250, v148, v68
    v_mfma_f32_32x32x16_bf16 v[88:103], v[204:207], v[164:167], v[88:103]
    v_mul_f32 v249, v133, v69
    v_mul_f32 v251, v149, v69
    v_fma_f32 v248, -v148, v84, v248
    v_fma_f32 v250, v132, v84, v250
    v_fma_f32 v249, -v149, v85, v249
    v_fma_f32 v251, v133, v85, v251
    v_cvt_pk_bf16_f32 v174, v248, v249
    v_cvt_pk_bf16_f32 v182, v250, v251
    v_mul_f32 v248, v134, v70
    v_mul_f32 v250, v150, v70
    v_mul_f32 v249, v135, v71
    v_mfma_f32_32x32x16_bf16 v[104:119], v[200:203], v[156:159], v[104:119]
    v_mul_f32 v251, v151, v71
    v_fma_f32 v248, -v150, v86, v248
    v_fma_f32 v250, v134, v86, v250
    v_fma_f32 v249, -v151, v87, v249
    v_fma_f32 v251, v135, v87, v251
    v_cvt_pk_bf16_f32 v175, v248, v249
    v_cvt_pk_bf16_f32 v183, v250, v251
    s_waitcnt lgkmcnt(5)
    v_mfma_f32_32x32x16_bf16 v[120:135], v[216:219], v[168:171], 0
    v_cvt_pk_bf16_f32 v24, v88, v89
    v_cvt_pk_bf16_f32 v25, v90, v91
    s_nop 0
    v_cvt_pk_bf16_f32 v28, v104, v105
    v_cvt_pk_bf16_f32 v29, v106, v107
    v_cvt_pk_bf16_f32 v32, v92, v93
    v_cvt_pk_bf16_f32 v33, v94, v95
    v_cvt_pk_bf16_f32 v36, v108, v109
    v_mfma_f32_32x32x16_bf16 v[136:151], v[216:219], v[176:179], 0
    v_cvt_pk_bf16_f32 v37, v110, v111
    v_cvt_pk_bf16_f32 v40, v96, v97
    v_cvt_pk_bf16_f32 v41, v98, v99
    v_cvt_pk_bf16_f32 v44, v112, v113
    v_cvt_pk_bf16_f32 v45, v114, v115
    v_cvt_pk_bf16_f32 v48, v100, v101
    v_cvt_pk_bf16_f32 v49, v102, v103
    v_cvt_pk_bf16_f32 v52, v116, v117
    v_cvt_pk_bf16_f32 v53, v118, v119
    s_waitcnt lgkmcnt(3)
    v_mfma_f32_32x32x16_bf16 v[120:135], v[224:227], v[176:179], v[120:135]
    v_mfma_f32_32x32x16_bf16 v[136:151], v[220:223], v[168:171], v[136:151]
    s_waitcnt lgkmcnt(2)
    v_mfma_f32_32x32x16_bf16 v[120:135], v[228:231], v[172:175], v[120:135]
    v_mfma_f32_32x32x16_bf16 v[136:151], v[228:231], v[180:183], v[136:151]
    s_waitcnt lgkmcnt(0)
    v_mfma_f32_32x32x16_bf16 v[120:135], v[236:239], v[180:183], v[120:135]
    v_mfma_f32_32x32x16_bf16 v[136:151], v[232:235], v[172:175], v[136:151]
    s_nop 10
    v_cvt_pk_bf16_f32 v26, v120, v121
    v_cvt_pk_bf16_f32 v27, v122, v123
    v_cvt_pk_bf16_f32 v30, v136, v137
    v_cvt_pk_bf16_f32 v31, v138, v139
    v_cvt_pk_bf16_f32 v34, v124, v125
    v_cvt_pk_bf16_f32 v35, v126, v127
    v_cvt_pk_bf16_f32 v38, v140, v141
    v_cvt_pk_bf16_f32 v39, v142, v143
    v_cvt_pk_bf16_f32 v42, v128, v129
    v_cvt_pk_bf16_f32 v43, v130, v131
    v_cvt_pk_bf16_f32 v46, v144, v145
    v_cvt_pk_bf16_f32 v47, v146, v147
    v_cvt_pk_bf16_f32 v50, v132, v133
    v_cvt_pk_bf16_f32 v51, v134, v135
    v_cvt_pk_bf16_f32 v54, v148, v149
    v_cvt_pk_bf16_f32 v55, v150, v151
    s_cmp_eq_u32 s39, 2
    s_cbranch_scc1 L_o_19
    s_add_u32 s44, s37, 0
    buffer_store_dwordx4 v[24:27], v16, s[16:19], s44 offen offset:0 sc1
    s_add_u32 s44, s37, 458752
    buffer_store_dwordx4 v[32:35], v16, s[16:19], s44 offen offset:0 sc1
    s_add_u32 s44, s37, 917504
    buffer_store_dwordx4 v[40:43], v16, s[16:19], s44 offen offset:0 sc1
    s_add_u32 s44, s37, 1376256
    buffer_store_dwordx4 v[48:51], v16, s[16:19], s44 offen offset:0 sc1
L_o_19:
    s_cmp_eq_u32 s39, 1
    s_cbranch_scc1 L_o_20
    s_add_u32 s44, s37, 0
    buffer_store_dwordx4 v[28:31], v16, s[16:19], s44 offen offset:64 sc1
    s_add_u32 s44, s37, 458752
    buffer_store_dwordx4 v[36:39], v16, s[16:19], s44 offen offset:64 sc1
    s_add_u32 s44, s37, 917504
    buffer_store_dwordx4 v[44:47], v16, s[16:19], s44 offen offset:64 sc1
    s_add_u32 s44, s37, 1376256
    buffer_store_dwordx4 v[52:55], v16, s[16:19], s44 offen offset:64 sc1
L_o_20:
    s_waitcnt vmcnt(0)
    s_barrier
    s_cmp_lg_u32 s28, 0
    s_cbranch_scc1 L_o_21
    v_lshlrev_b32 v12, 6, v0
    buffer_atomic_swap v4, v12, s[16:19], s38 offen sc1
    s_cmp_lg_u32 s59, 28
    s_cbranch_scc1 L_o_22
    s_sub_u32 s38, s38, 64
    buffer_atomic_swap v4, v12, s[16:19], s38 offen sc1
L_o_22:
L_o_21:
L_sfin:
    s_endpgm
L_end:
    s_endpgm
.fill 8320 - (. - recurrent_scan__spectral_gfnet__swiglu_ffn__prompt_kernel) / 4, 4, 0xbf810000
.section .rodata,"a"
.p2align 6
.amdhsa_kernel recurrent_scan__spectral_gfnet__swiglu_ffn__prompt_kernel
  .amdhsa_next_free_vgpr 256
  .amdhsa_next_free_sgpr 102
  .amdhsa_accum_offset 256
  .amdhsa_group_segment_fixed_size 0
  .amdhsa_kernarg_size 80
  .amdhsa_user_sgpr_count 2
  .amdhsa_user_sgpr_kernarg_segment_ptr 1
  .amdhsa_system_sgpr_workgroup_id_x 1
.end_amdhsa_kernel
```
